```python
import torch

def _softmax(x, axis=-1):
    return torch.softmax(x, dim=axis)
def _gelu(x):
    return torch.nn.functional.gelu(x, approximate="tanh")
def _silu(x):
    return torch.nn.functional.silu(x)
def _sigmoid(x):
    return torch.sigmoid(x)
def _layernorm(x, axis=-1, eps=1e-5):
    m = x.mean(dim=axis, keepdim=True)
    v = x.var(dim=axis, keepdim=True, unbiased=False)
    return (x - m) / torch.sqrt(v + eps)
def _scatter_add(tgt, idx, src, axis=0):
    return tgt.clone().index_add_(axis, idx, src)
def _segment_sum(src, seg, n):
    out = torch.zeros((n,) + src.shape[1:], dtype=src.dtype)
    return out.index_add_(0, seg, src)
def _pad(x, pw):
    flat = tuple(v for pair in reversed(pw) for v in pair)
    return torch.nn.functional.pad(x, flat)

kernel_name = 'concat_heads__ssm_conv_h3__mha_block__prompt'

def setup_inputs():

    _w = (lambda a: (lambda t: t.to(torch.bfloat16) if t.is_floating_point() else t)(torch.as_tensor(a)))
    def _A_setup():
        B, S, D = 1, 2048, 1024
        ks = 4
        return {
            "q": _w((lambda *s: torch.randn(*s, dtype=torch.bfloat16) * 0.05)(B, S, D)),
            "k": _w((lambda *s: torch.randn(*s, dtype=torch.bfloat16) * 0.8)(B, S, D)),
            "v": _w((lambda *s: torch.randn(*s, dtype=torch.bfloat16) * 0.8)(B, S, D)),
            "shift_k": _w((lambda *s: torch.randn(*s, dtype=torch.bfloat16) * 0.8)(D, ks) * 0.5),
            "ssm_k": _w((lambda *s: torch.randn(*s, dtype=torch.bfloat16) * 0.8)(D, S) * (1.0 / S ** 0.5)),
            "ssm_D": _w((lambda *s: torch.randn(*s, dtype=torch.bfloat16) * 0.8)(D)),
        }
    _A_in = _A_setup()

    def _B_setup():
        B, S, D, H = 1, 2048, 1024, 32
        return {
            "x": _w((lambda *s: torch.randn(*s, dtype=torch.bfloat16) * 0.2)(B, S, D)),
            "wqkv": _w((lambda *s: torch.randn(*s, dtype=torch.bfloat16) * 0.2)(D, 3 * D)),
            "wo": _w((lambda *s: torch.randn(*s, dtype=torch.bfloat16) * 0.05)(D, D)),
        }
    _B_in = _B_setup()

    return {
        "A_q": _A_in["q"],
        "A_k": _A_in["k"],
        "A_v": _A_in["v"],
        "A_shift_k": _A_in["shift_k"],
        "A_ssm_k": _A_in["ssm_k"],
        "A_ssm_D": _A_in["ssm_D"],
        "B_x": _B_in["x"],
        "B_wqkv": _B_in["wqkv"],
        "B_wo": _B_in["wo"],
    }

def reference(A_q, A_k, A_v, A_shift_k, A_ssm_k, A_ssm_D, B_x, B_wqkv, B_wo):
    def _A_ref(q, k, v, shift_k, ssm_k, ssm_D):
        B, S, D = q.shape
        ks = shift_k.shape[-1]
        k_pad = _pad(k, ((0, 0), (ks - 1, 0), (0, 0)))
        k_shift = torch.zeros_like(k)
        for t in range(ks):
            k_shift = k_shift + k_pad[:, t:t + S, :] * shift_k[:, ks - 1 - t][None, None, :]
        kv = k_shift * v
        L = 2 * S
        kv_pad = _pad(kv, ((0, 0), (0, S), (0, 0)))
        kf_pad = _pad(ssm_k, ((0, 0), (0, S)))
        kv_f = (lambda x, axes=(-2,-1): torch.fft.rfft2(x.float(), dim=axes))(kv_pad[:, None, :, :], axes=(1, 2))
        kf_f = (lambda x, axes=(-2,-1): torch.fft.rfft2(x.float(), dim=axes))(kf_pad[:, None, :], axes=(1, 2))
        kf_f = (lambda x, *d: x.permute(*d))(kf_f, 1, 2, 0)
        y_f = kv_f * kf_f[None, :, :, :]
        y = (lambda x, s, axes=(-2,-1): torch.fft.irfft2(x, s=s, dim=axes).to(torch.bfloat16))(y_f, (1, L), axes=(1, 2))[:, 0, :S, :]
        y = y + kv * ssm_D[None, None, :]
        return q * y

    def _B_ref(x, wqkv, wo):
        B, S, D = x.shape
        H = 32
        Dh = D // H
        qkv = (lambda x, *d: x.permute(*d))((x @ wqkv).reshape(B, S, 3, H, Dh), 2, 0, 3, 1, 4)
        q, k, v = qkv[0], qkv[1], qkv[2]
        scores = torch.einsum("bhqd,bhkd->bhqk", q, k) * (Dh ** -0.5)
        p = _softmax(scores, axis=-1)
        o = torch.einsum("bhqk,bhkd->bhqd", p, v)
        return (lambda x, *d: x.permute(*d))(o, 0, 2, 1, 3).reshape(B, S, D) @ wo

    a = _A_ref(A_q, A_k, A_v, A_shift_k, A_ssm_k, A_ssm_D)
    b = _B_ref(B_x, B_wqkv, B_wo)
    return torch.concatenate([a, b], axis=-1)
```

```asm
; @launch grid=(256,1,1) block=(512,1,1) lds=163840
.amdgcn_target "amdgcn-amd-amdhsa--gfx950"
.text
.globl concat_heads__ssm_conv_h3__mha_block__prompt_kernel
.p2align 8
.type concat_heads__ssm_conv_h3__mha_block__prompt_kernel,@function
concat_heads__ssm_conv_h3__mha_block__prompt_kernel:
    s_cmp_ge_u32 s2, 256
    s_cbranch_scc1 K_END
    s_load_dwordx16 s[16:31], s[0:1], 0
    s_load_dwordx8 s[32:39], s[0:1], 64
    v_lshrrev_b32 v1, 6, v0
    v_and_b32 v0, 63, v0
    v_readfirstlane_b32 s3, v1
    s_lshr_b32 s4, s2, 1
    s_xor_b32 s4, s4, s2
    s_and_b32 s4, s4, 1
    s_lshl_b32 s4, s4, 3
    s_bfe_u32 s5, s2, 0x30003
    s_or_b32 s4, s4, s5
    s_bfe_u32 s5, s2, 0x20001
    s_lshl_b32 s5, s5, 2
    s_lshr_b32 s6, s2, 6
    s_or_b32 s5, s5, s6
    v_lshlrev_b32 v1, 4, v0
    v_mov_b32 v2, 0
    v_and_b32 v254, 15, v0
    v_lshlrev_b32 v254, 7, v254
    s_cmp_lt_u32 s3, 4
    s_cbranch_scc0 P1_LOADER
    s_and_b32 s6, s2, 0x30
    s_cbranch_scc1 P1_COMPUTE
    s_getpc_b64 s[40:41]
    s_bfe_u32 s6, s2, 0x10003
    s_lshl_b32 s6, s6, 2
    s_add_u32 s6, s6, s3
    s_min_u32 s6, s6, 4
    s_lshl_b32 s6, s6, 13
    v_lshl_add_u32 v3, v0, 7, s6
    global_load_dword v255, v3, s[40:41]
    s_branch P1_COMPUTE
P1_LOADER:
    s_sub_u32 s6, s3, 4
    v_lshrrev_b32 v3, 3, v0
    v_and_b32 v4, 7, v0
    v_lshrrev_b32 v11, 4, v0
    v_xor_b32 v5, v4, v11
    v_lshlrev_b32 v5, 4, v5
    v_lshl_add_u32 v5, v3, 11, v5
    v_xor_b32 v6, 64, v5
    v_add_u32 v6, 15360, v6
    v_add_u32 v7, 30720, v5
    v_add_u32 v8, 30720, v6
    v_and_b32 v9, 1, v11
    v_lshlrev_b32 v9, 2, v9
    v_xor_b32 v9, v9, v4
    v_lshlrev_b32 v9, 4, v9
    v_mul_u32_u24 v10, 6144, v3
    v_add_u32 v9, v9, v10
    v_add_u32 v10, 48128, v9
    s_lshl_b32 s12, s4, 18
    s_lshl_b32 s13, s6, 16
    s_add_u32 s96, s12, s13
    s_mul_i32 s13, s6, 98304
    s_lshl_b32 s14, s5, 7
    s_add_u32 s97, s13, s14
    s_add_u32 s95, s4, s5
    s_add_u32 s94, s95, s5
    s_and_b32 s94, s94, 7
    s_and_b32 s95, s95, 3
    s_mul_i32 s15, s6, 10240
    s_waitcnt lgkmcnt(0)
    s_mov_b32 s40, s28
    s_and_b32 s41, s29, 0xffff
    s_mov_b32 s42, 4194304
    s_mov_b32 s43, 0x00020000
    s_mov_b32 s44, s30
    s_and_b32 s45, s31, 0xffff
    s_mov_b32 s46, 6291456
    s_mov_b32 s47, 0x00020000
    s_xor_b32 s14, s95, 0
    s_lshl_b32 s12, s14, 7
    s_add_u32 m0, s15, 0
    s_add_u32 s12, s12, s96
    buffer_load_dwordx4 v5, s[40:43], s12 offen offset:0 lds
    buffer_load_dwordx4 v6, s[40:43], s12 offen offset:1024 lds
    buffer_load_dwordx4 v7, s[40:43], s12 offen offset:2048 lds
    buffer_load_dwordx4 v8, s[40:43], s12 offen offset:3072 lds
    s_mul_i32 s14, s14, 393216
    s_add_u32 m0, s15, 4096
    s_add_u32 s13, s14, s97
    buffer_load_dwordx4 v9, s[44:47], s13 offen offset:0 lds
    buffer_load_dwordx4 v10, s[44:47], s13 offen offset:1024 lds
    buffer_load_dwordx4 v9, s[44:47], s13 offen offset:2048 lds
    buffer_load_dwordx4 v10, s[44:47], s13 offen offset:3072 lds
    s_add_u32 m0, s15, 8192
    s_add_u32 s13, s13, 4096
    buffer_load_dwordx4 v9, s[44:47], s13 offen offset:0 lds
    buffer_load_dwordx4 v10, s[44:47], s13 offen offset:1024 lds
    s_xor_b32 s14, s95, 1
    s_lshl_b32 s12, s14, 7
    s_add_u32 m0, s15, 40960
    s_add_u32 s12, s12, s96
    buffer_load_dwordx4 v5, s[40:43], s12 offen offset:0 lds
    buffer_load_dwordx4 v6, s[40:43], s12 offen offset:1024 lds
    buffer_load_dwordx4 v7, s[40:43], s12 offen offset:2048 lds
    buffer_load_dwordx4 v8, s[40:43], s12 offen offset:3072 lds
    s_mul_i32 s14, s14, 393216
    s_add_u32 m0, s15, 45056
    s_add_u32 s13, s14, s97
    buffer_load_dwordx4 v9, s[44:47], s13 offen offset:0 lds
    buffer_load_dwordx4 v10, s[44:47], s13 offen offset:1024 lds
    buffer_load_dwordx4 v9, s[44:47], s13 offen offset:2048 lds
    buffer_load_dwordx4 v10, s[44:47], s13 offen offset:3072 lds
    s_add_u32 m0, s15, 49152
    s_add_u32 s13, s13, 4096
    buffer_load_dwordx4 v9, s[44:47], s13 offen offset:0 lds
    buffer_load_dwordx4 v10, s[44:47], s13 offen offset:1024 lds
    s_mov_b32 s48, s18
    s_and_b32 s49, s19, 0xffff
    s_mov_b32 s50, 4194304
    s_mov_b32 s51, 0x00020000
    s_mov_b32 s52, s20
    s_and_b32 s53, s21, 0xffff
    s_mov_b32 s54, 4194304
    s_mov_b32 s55, 0x00020000
    s_mov_b32 s60, s22
    s_and_b32 s61, s23, 0xffff
    s_mov_b32 s62, 8192
    s_mov_b32 s63, 0x00020000
    s_lshr_b32 s7, s2, 4
    s_lshl_b32 s7, s7, 7
    s_lshl_b32 s64, s6, 5
    s_add_u32 s7, s7, s64
    s_and_b32 s64, s2, 15
    s_lshl_b32 s64, s64, 6
    v_lshl_add_u32 v11, v11, 3, s7
    v_and_b32 v12, 15, v0
    v_lshl_add_u32 v12, v12, 2, s64
    v_lshlrev_b32 v13, 1, v12
    v_lshl_add_u32 v15, v11, 11, v13
    v_subrev_u32 v13, 6144, v15
    v_subrev_u32 v14, 2048, v15
    v_lshlrev_b32 v17, 3, v12
    s_movk_i32 s64, 0x1000
    s_movk_i32 s65, 0x2000
    s_movk_i32 s66, 0x3000
    buffer_load_dwordx4 v[60:63], v17, s[60:63], 0 offen offset:0
    buffer_load_dwordx4 v[64:67], v17, s[60:63], 0 offen offset:16
    buffer_load_dwordx2 v[20:21], v13, s[48:51], 0 offen offset:0 nt
    buffer_load_dwordx2 v[22:23], v13, s[48:51], 0 offen offset:2048 nt
    buffer_load_dwordx2 v[24:25], v14, s[48:51], 0 offen offset:0 nt
    buffer_load_dwordx2 v[26:27], v15, s[48:51], 0 offen offset:0 nt
    buffer_load_dwordx2 v[28:29], v15, s[48:51], 0 offen offset:2048 nt
    buffer_load_dwordx2 v[30:31], v15, s[48:51], s64 offen offset:0 nt
    buffer_load_dwordx2 v[32:33], v15, s[48:51], s64 offen offset:2048 nt
    buffer_load_dwordx2 v[34:35], v15, s[48:51], s65 offen offset:0 nt
    buffer_load_dwordx2 v[36:37], v15, s[48:51], s65 offen offset:2048 nt
    buffer_load_dwordx2 v[38:39], v15, s[48:51], s66 offen offset:0 nt
    buffer_load_dwordx2 v[40:41], v15, s[48:51], s66 offen offset:2048 nt
    buffer_load_dwordx2 v[42:43], v15, s[52:55], 0 offen offset:0 nt
    buffer_load_dwordx2 v[44:45], v15, s[52:55], 0 offen offset:2048 nt
    buffer_load_dwordx2 v[46:47], v15, s[52:55], s64 offen offset:0 nt
    buffer_load_dwordx2 v[48:49], v15, s[52:55], s64 offen offset:2048 nt
    buffer_load_dwordx2 v[50:51], v15, s[52:55], s65 offen offset:0 nt
    buffer_load_dwordx2 v[52:53], v15, s[52:55], s65 offen offset:2048 nt
    buffer_load_dwordx2 v[54:55], v15, s[52:55], s66 offen offset:0 nt
    buffer_load_dwordx2 v[56:57], v15, s[52:55], s66 offen offset:2048 nt
    v_sub_u32 v18, 2040, v11
    v_lshlrev_b32 v18, 1, v18
    v_lshl_add_u32 v18, v12, 12, v18
    v_add_u32 v18, 16777216, v18
    s_mov_b32 s8, s38
    s_and_b32 s9, s39, 0xffff
    s_mov_b32 s10, 25296896
    s_mov_b32 s11, 0x00020000
    s_mov_b32 s56, s36
    s_and_b32 s57, s37, 0xffff
    s_mov_b32 s58, 256
    s_mov_b32 s59, 0x00020000
    s_waitcnt vmcnt(31)
    s_barrier
    s_xor_b32 s14, s95, 2
    s_lshl_b32 s12, s14, 7
    s_add_u32 m0, s15, 81920
    s_add_u32 s12, s12, s96
    buffer_load_dwordx4 v5, s[40:43], s12 offen offset:0 lds
    buffer_load_dwordx4 v6, s[40:43], s12 offen offset:1024 lds
    buffer_load_dwordx4 v7, s[40:43], s12 offen offset:2048 lds
    buffer_load_dwordx4 v8, s[40:43], s12 offen offset:3072 lds
    s_mul_i32 s14, s14, 393216
    s_add_u32 m0, s15, 86016
    s_add_u32 s13, s14, s97
    buffer_load_dwordx4 v9, s[44:47], s13 offen offset:0 lds
    buffer_load_dwordx4 v10, s[44:47], s13 offen offset:1024 lds
    buffer_load_dwordx4 v9, s[44:47], s13 offen offset:2048 lds
    buffer_load_dwordx4 v10, s[44:47], s13 offen offset:3072 lds
    s_add_u32 m0, s15, 90112
    s_add_u32 s13, s13, 4096
    buffer_load_dwordx4 v9, s[44:47], s13 offen offset:0 lds
    buffer_load_dwordx4 v10, s[44:47], s13 offen offset:1024 lds
    s_xor_b32 s14, s95, 3
    s_lshl_b32 s12, s14, 7
    s_add_u32 m0, s15, 122880
    s_add_u32 s12, s12, s96
    buffer_load_dwordx4 v5, s[40:43], s12 offen offset:0 lds
    buffer_load_dwordx4 v6, s[40:43], s12 offen offset:1024 lds
    buffer_load_dwordx4 v7, s[40:43], s12 offen offset:2048 lds
    buffer_load_dwordx4 v8, s[40:43], s12 offen offset:3072 lds
    s_mul_i32 s14, s14, 393216
    s_add_u32 m0, s15, 126976
    s_add_u32 s13, s14, s97
    buffer_load_dwordx4 v9, s[44:47], s13 offen offset:0 lds
    buffer_load_dwordx4 v10, s[44:47], s13 offen offset:1024 lds
    buffer_load_dwordx4 v9, s[44:47], s13 offen offset:2048 lds
    buffer_load_dwordx4 v10, s[44:47], s13 offen offset:3072 lds
    s_add_u32 m0, s15, 131072
    s_add_u32 s13, s13, 4096
    buffer_load_dwordx4 v9, s[44:47], s13 offen offset:0 lds
    buffer_load_dwordx4 v10, s[44:47], s13 offen offset:1024 lds
    s_lshl_b32 s7, s2, 2
    s_add_u32 s7, s7, s6
    s_lshl_b32 s64, s7, 12
    s_mul_i32 s65, s6, 4160
    s_mul_i32 s66, s6, 4608
    s_add_u32 s66, s66, 66816
    s_mov_b32 s48, s24
    s_and_b32 s49, s25, 0xffff
    s_mov_b32 s50, 4194304
    s_mov_b32 s51, 0x00020000
    s_mov_b32 s52, s26
    s_and_b32 s53, s27, 0xffff
    s_mov_b32 s54, 2048
    s_mov_b32 s55, 0x00020000
    v_add_u32 v205, s65, v1
    s_lshr_b32 s7, s64, 12
    buffer_load_dwordx4 v[120:123], v1, s[48:51], s64 offen offset:0 nt
    buffer_load_dwordx4 v[128:131], v1, s[48:51], s64 offen offset:1024 nt
    buffer_load_dwordx4 v[136:139], v1, s[48:51], s64 offen offset:2048 nt
    buffer_load_dwordx4 v[144:147], v1, s[48:51], s64 offen offset:3072 nt
    buffer_load_dwordx2 v[124:125], v1, s[48:51], s64 offen offset:16 nt
    buffer_load_dwordx2 v[132:133], v1, s[48:51], s64 offen offset:1040 nt
    buffer_load_dwordx2 v[140:141], v1, s[48:51], s64 offen offset:2064 nt
    buffer_load_dwordx2 v[148:149], v1, s[48:51], s64 offen offset:3088 nt
    buffer_load_dwordx2 v[200:201], v2, s[48:51], s64 offen
    s_lshl_b32 s7, s7, 1
    buffer_load_ushort v202, v2, s[52:55], s7 offen
    s_waitcnt vmcnt(51)
    s_barrier
    s_xor_b32 s14, s95, 4
    s_lshl_b32 s12, s14, 7
    s_add_u32 m0, s15, 0
    s_add_u32 s12, s12, s96
    buffer_load_dwordx4 v5, s[40:43], s12 offen offset:0 lds
    buffer_load_dwordx4 v6, s[40:43], s12 offen offset:1024 lds
    buffer_load_dwordx4 v7, s[40:43], s12 offen offset:2048 lds
    buffer_load_dwordx4 v8, s[40:43], s12 offen offset:3072 lds
    s_mul_i32 s14, s14, 393216
    s_add_u32 m0, s15, 4096
    s_add_u32 s13, s14, s97
    buffer_load_dwordx4 v9, s[44:47], s13 offen offset:0 lds
    buffer_load_dwordx4 v10, s[44:47], s13 offen offset:1024 lds
    buffer_load_dwordx4 v9, s[44:47], s13 offen offset:2048 lds
    buffer_load_dwordx4 v10, s[44:47], s13 offen offset:3072 lds
    s_add_u32 m0, s15, 8192
    s_add_u32 s13, s13, 4096
    buffer_load_dwordx4 v9, s[44:47], s13 offen offset:0 lds
    buffer_load_dwordx4 v10, s[44:47], s13 offen offset:1024 lds
    s_waitcnt vmcnt(30)
    s_barrier
    s_xor_b32 s14, s95, 5
    s_lshl_b32 s12, s14, 7
    s_add_u32 m0, s15, 40960
    s_add_u32 s12, s12, s96
    buffer_load_dwordx4 v5, s[40:43], s12 offen offset:0 lds
    buffer_load_dwordx4 v6, s[40:43], s12 offen offset:1024 lds
    buffer_load_dwordx4 v7, s[40:43], s12 offen offset:2048 lds
    buffer_load_dwordx4 v8, s[40:43], s12 offen offset:3072 lds
    s_mul_i32 s14, s14, 393216
    s_add_u32 m0, s15, 45056
    s_add_u32 s13, s14, s97
    buffer_load_dwordx4 v9, s[44:47], s13 offen offset:0 lds
    buffer_load_dwordx4 v10, s[44:47], s13 offen offset:1024 lds
    buffer_load_dwordx4 v9, s[44:47], s13 offen offset:2048 lds
    buffer_load_dwordx4 v10, s[44:47], s13 offen offset:3072 lds
    s_add_u32 m0, s15, 49152
    s_add_u32 s13, s13, 4096
    buffer_load_dwordx4 v9, s[44:47], s13 offen offset:0 lds
    buffer_load_dwordx4 v10, s[44:47], s13 offen offset:1024 lds
    s_waitcnt vmcnt(30)
    s_barrier
    s_xor_b32 s14, s95, 6
    s_lshl_b32 s12, s14, 7
    s_add_u32 m0, s15, 81920
    s_add_u32 s12, s12, s96
    buffer_load_dwordx4 v5, s[40:43], s12 offen offset:0 lds
    v_lshlrev_b32 v68, 16, v20
    v_lshlrev_b32 v69, 16, v22
    v_lshlrev_b32 v70, 16, v24
    v_lshlrev_b32 v71, 16, v26
    v_lshlrev_b32 v72, 16, v28
    v_lshlrev_b32 v73, 16, v30
    v_lshlrev_b32 v74, 16, v32
    v_lshlrev_b32 v75, 16, v34
    v_lshlrev_b32 v76, 16, v36
    buffer_load_dwordx4 v6, s[40:43], s12 offen offset:1024 lds
    v_lshlrev_b32 v77, 16, v38
    v_lshlrev_b32 v78, 16, v40
    v_lshlrev_b32 v79, 16, v60
    v_and_b32 v80, 0xffff0000, v60
    v_lshlrev_b32 v81, 16, v61
    v_and_b32 v82, 0xffff0000, v61
    v_mul_f32 v83, v68, v82
    v_mul_f32 v84, v69, v82
    v_mul_f32 v85, v70, v82
    buffer_load_dwordx4 v7, s[40:43], s12 offen offset:2048 lds
    v_mul_f32 v86, v71, v82
    v_mul_f32 v87, v72, v82
    v_mul_f32 v88, v73, v82
    v_mul_f32 v89, v74, v82
    v_mul_f32 v90, v75, v82
    v_fmac_f32 v83, v69, v81
    v_fmac_f32 v84, v70, v81
    v_fmac_f32 v85, v71, v81
    v_fmac_f32 v86, v72, v81
    buffer_load_dwordx4 v8, s[40:43], s12 offen offset:3072 lds
    v_fmac_f32 v87, v73, v81
    v_fmac_f32 v88, v74, v81
    v_fmac_f32 v89, v75, v81
    v_fmac_f32 v90, v76, v81
    v_fmac_f32 v83, v70, v80
    v_fmac_f32 v84, v71, v80
    v_fmac_f32 v85, v72, v80
    v_fmac_f32 v86, v73, v80
    v_fmac_f32 v87, v74, v80
    s_mul_i32 s14, s14, 393216
    s_add_u32 m0, s15, 86016
    s_add_u32 s13, s14, s97
    buffer_load_dwordx4 v9, s[44:47], s13 offen offset:0 lds
    v_fmac_f32 v88, v75, v80
    v_fmac_f32 v89, v76, v80
    v_fmac_f32 v90, v77, v80
    v_fmac_f32 v83, v71, v79
    v_fmac_f32 v84, v72, v79
    v_fmac_f32 v85, v73, v79
    v_fmac_f32 v86, v74, v79
    v_fmac_f32 v87, v75, v79
    v_fmac_f32 v88, v76, v79
    buffer_load_dwordx4 v10, s[44:47], s13 offen offset:1024 lds
    v_fmac_f32 v89, v77, v79
    v_fmac_f32 v90, v78, v79
    v_lshlrev_b32 v68, 16, v42
    v_lshlrev_b32 v69, 16, v44
    v_lshlrev_b32 v70, 16, v46
    v_lshlrev_b32 v71, 16, v48
    v_lshlrev_b32 v72, 16, v50
    v_lshlrev_b32 v73, 16, v52
    v_lshlrev_b32 v74, 16, v54
    buffer_load_dwordx4 v9, s[44:47], s13 offen offset:2048 lds
    v_lshlrev_b32 v75, 16, v56
    v_mul_f32 v83, v83, v68
    v_mul_f32 v84, v84, v69
    v_mul_f32 v85, v85, v70
    v_mul_f32 v86, v86, v71
    v_mul_f32 v87, v87, v72
    v_mul_f32 v88, v88, v73
    v_mul_f32 v89, v89, v74
    v_mul_f32 v90, v90, v75
    buffer_load_dwordx4 v10, s[44:47], s13 offen offset:3072 lds
    v_cvt_pk_bf16_f32 v104, v90, v89
    v_cvt_pk_bf16_f32 v105, v88, v87
    v_cvt_pk_bf16_f32 v106, v86, v85
    v_cvt_pk_bf16_f32 v107, v84, v83
    v_and_b32 v68, 0xffff0000, v20
    v_and_b32 v69, 0xffff0000, v22
    v_and_b32 v70, 0xffff0000, v24
    v_and_b32 v71, 0xffff0000, v26
    v_and_b32 v72, 0xffff0000, v28
    s_add_u32 m0, s15, 90112
    s_add_u32 s13, s13, 4096
    buffer_load_dwordx4 v9, s[44:47], s13 offen offset:0 lds
    v_and_b32 v73, 0xffff0000, v30
    v_and_b32 v74, 0xffff0000, v32
    v_and_b32 v75, 0xffff0000, v34
    v_and_b32 v76, 0xffff0000, v36
    v_and_b32 v77, 0xffff0000, v38
    v_and_b32 v78, 0xffff0000, v40
    v_lshlrev_b32 v79, 16, v62
    v_and_b32 v80, 0xffff0000, v62
    v_lshlrev_b32 v81, 16, v63
    buffer_load_dwordx4 v10, s[44:47], s13 offen offset:1024 lds
    v_and_b32 v82, 0xffff0000, v63
    v_mul_f32 v83, v68, v82
    v_mul_f32 v84, v69, v82
    v_mul_f32 v85, v70, v82
    v_mul_f32 v86, v71, v82
    v_mul_f32 v87, v72, v82
    v_mul_f32 v88, v73, v82
    v_mul_f32 v89, v74, v82
    v_mul_f32 v90, v75, v82
    s_waitcnt vmcnt(20)
    s_barrier
    s_xor_b32 s14, s95, 7
    s_lshl_b32 s12, s14, 7
    s_add_u32 m0, s15, 122880
    s_add_u32 s12, s12, s96
    buffer_load_dwordx4 v5, s[40:43], s12 offen offset:0 lds
    v_fmac_f32 v83, v69, v81
    v_fmac_f32 v84, v70, v81
    v_fmac_f32 v85, v71, v81
    v_fmac_f32 v86, v72, v81
    v_fmac_f32 v87, v73, v81
    v_fmac_f32 v88, v74, v81
    v_fmac_f32 v89, v75, v81
    v_fmac_f32 v90, v76, v81
    v_fmac_f32 v83, v70, v80
    buffer_load_dwordx4 v6, s[40:43], s12 offen offset:1024 lds
    v_fmac_f32 v84, v71, v80
    v_fmac_f32 v85, v72, v80
    v_fmac_f32 v86, v73, v80
    v_fmac_f32 v87, v74, v80
    v_fmac_f32 v88, v75, v80
    v_fmac_f32 v89, v76, v80
    v_fmac_f32 v90, v77, v80
    v_fmac_f32 v83, v71, v79
    v_fmac_f32 v84, v72, v79
    buffer_load_dwordx4 v7, s[40:43], s12 offen offset:2048 lds
    v_fmac_f32 v85, v73, v79
    v_fmac_f32 v86, v74, v79
    v_fmac_f32 v87, v75, v79
    v_fmac_f32 v88, v76, v79
    v_fmac_f32 v89, v77, v79
    v_fmac_f32 v90, v78, v79
    v_and_b32 v68, 0xffff0000, v42
    v_and_b32 v69, 0xffff0000, v44
    v_and_b32 v70, 0xffff0000, v46
    buffer_load_dwordx4 v8, s[40:43], s12 offen offset:3072 lds
    v_and_b32 v71, 0xffff0000, v48
    v_and_b32 v72, 0xffff0000, v50
    v_and_b32 v73, 0xffff0000, v52
    v_and_b32 v74, 0xffff0000, v54
    v_and_b32 v75, 0xffff0000, v56
    v_mul_f32 v83, v83, v68
    v_mul_f32 v84, v84, v69
    v_mul_f32 v85, v85, v70
    v_mul_f32 v86, v86, v71
    s_mul_i32 s14, s14, 393216
    s_add_u32 m0, s15, 126976
    s_add_u32 s13, s14, s97
    buffer_load_dwordx4 v9, s[44:47], s13 offen offset:0 lds
    v_mul_f32 v87, v87, v72
    v_mul_f32 v88, v88, v73
    v_mul_f32 v89, v89, v74
    v_mul_f32 v90, v90, v75
    v_cvt_pk_bf16_f32 v108, v90, v89
    v_cvt_pk_bf16_f32 v109, v88, v87
    v_cvt_pk_bf16_f32 v110, v86, v85
    v_cvt_pk_bf16_f32 v111, v84, v83
    v_lshlrev_b32 v68, 16, v21
    buffer_load_dwordx4 v10, s[44:47], s13 offen offset:1024 lds
    v_lshlrev_b32 v69, 16, v23
    v_lshlrev_b32 v70, 16, v25
    v_lshlrev_b32 v71, 16, v27
    v_lshlrev_b32 v72, 16, v29
    v_lshlrev_b32 v73, 16, v31
    v_lshlrev_b32 v74, 16, v33
    v_lshlrev_b32 v75, 16, v35
    v_lshlrev_b32 v76, 16, v37
    v_lshlrev_b32 v77, 16, v39
    buffer_load_dwordx4 v9, s[44:47], s13 offen offset:2048 lds
    v_lshlrev_b32 v78, 16, v41
    v_lshlrev_b32 v79, 16, v64
    v_and_b32 v80, 0xffff0000, v64
    v_lshlrev_b32 v81, 16, v65
    v_and_b32 v82, 0xffff0000, v65
    v_mul_f32 v83, v68, v82
    v_mul_f32 v84, v69, v82
    v_mul_f32 v85, v70, v82
    v_mul_f32 v86, v71, v82
    buffer_load_dwordx4 v10, s[44:47], s13 offen offset:3072 lds
    v_mul_f32 v87, v72, v82
    v_mul_f32 v88, v73, v82
    v_mul_f32 v89, v74, v82
    v_mul_f32 v90, v75, v82
    v_fmac_f32 v83, v69, v81
    v_fmac_f32 v84, v70, v81
    v_fmac_f32 v85, v71, v81
    v_fmac_f32 v86, v72, v81
    v_fmac_f32 v87, v73, v81
    s_add_u32 m0, s15, 131072
    s_add_u32 s13, s13, 4096
    buffer_load_dwordx4 v9, s[44:47], s13 offen offset:0 lds
    v_fmac_f32 v88, v74, v81
    v_fmac_f32 v89, v75, v81
    v_fmac_f32 v90, v76, v81
    v_fmac_f32 v83, v70, v80
    v_fmac_f32 v84, v71, v80
    v_fmac_f32 v85, v72, v80
    v_fmac_f32 v86, v73, v80
    v_fmac_f32 v87, v74, v80
    v_fmac_f32 v88, v75, v80
    buffer_load_dwordx4 v10, s[44:47], s13 offen offset:1024 lds
    v_fmac_f32 v89, v76, v80
    v_fmac_f32 v90, v77, v80
    v_fmac_f32 v83, v71, v79
    v_fmac_f32 v84, v72, v79
    v_fmac_f32 v85, v73, v79
    v_fmac_f32 v86, v74, v79
    v_fmac_f32 v87, v75, v79
    v_fmac_f32 v88, v76, v79
    v_fmac_f32 v89, v77, v79
    s_waitcnt vmcnt(20)
    s_barrier
    s_xor_b32 s14, s95, 8
    s_lshl_b32 s12, s14, 7
    s_add_u32 m0, s15, 0
    s_add_u32 s12, s12, s96
    buffer_load_dwordx4 v5, s[40:43], s12 offen offset:0 lds
    v_fmac_f32 v90, v78, v79
    v_lshlrev_b32 v68, 16, v43
    v_lshlrev_b32 v69, 16, v45
    v_lshlrev_b32 v70, 16, v47
    v_lshlrev_b32 v71, 16, v49
    v_lshlrev_b32 v72, 16, v51
    v_lshlrev_b32 v73, 16, v53
    v_lshlrev_b32 v74, 16, v55
    v_lshlrev_b32 v75, 16, v57
    buffer_load_dwordx4 v6, s[40:43], s12 offen offset:1024 lds
    v_mul_f32 v83, v83, v68
    v_mul_f32 v84, v84, v69
    v_mul_f32 v85, v85, v70
    v_mul_f32 v86, v86, v71
    v_mul_f32 v87, v87, v72
    v_mul_f32 v88, v88, v73
    v_mul_f32 v89, v89, v74
    v_mul_f32 v90, v90, v75
    v_cvt_pk_bf16_f32 v112, v90, v89
    buffer_load_dwordx4 v7, s[40:43], s12 offen offset:2048 lds
    v_cvt_pk_bf16_f32 v113, v88, v87
    v_cvt_pk_bf16_f32 v114, v86, v85
    v_cvt_pk_bf16_f32 v115, v84, v83
    v_and_b32 v68, 0xffff0000, v21
    v_and_b32 v69, 0xffff0000, v23
    v_and_b32 v70, 0xffff0000, v25
    v_and_b32 v71, 0xffff0000, v27
    v_and_b32 v72, 0xffff0000, v29
    v_and_b32 v73, 0xffff0000, v31
    buffer_load_dwordx4 v8, s[40:43], s12 offen offset:3072 lds
    v_and_b32 v74, 0xffff0000, v33
    v_and_b32 v75, 0xffff0000, v35
    v_and_b32 v76, 0xffff0000, v37
    v_and_b32 v77, 0xffff0000, v39
    v_and_b32 v78, 0xffff0000, v41
    v_lshlrev_b32 v79, 16, v66
    v_and_b32 v80, 0xffff0000, v66
    v_lshlrev_b32 v81, 16, v67
    v_and_b32 v82, 0xffff0000, v67
    s_mul_i32 s14, s14, 393216
    s_add_u32 m0, s15, 4096
    s_add_u32 s13, s14, s97
    buffer_load_dwordx4 v9, s[44:47], s13 offen offset:0 lds
    v_mul_f32 v83, v68, v82
    v_mul_f32 v84, v69, v82
    v_mul_f32 v85, v70, v82
    v_mul_f32 v86, v71, v82
    v_mul_f32 v87, v72, v82
    v_mul_f32 v88, v73, v82
    v_mul_f32 v89, v74, v82
    v_mul_f32 v90, v75, v82
    v_fmac_f32 v83, v69, v81
    buffer_load_dwordx4 v10, s[44:47], s13 offen offset:1024 lds
    v_fmac_f32 v84, v70, v81
    v_fmac_f32 v85, v71, v81
    v_fmac_f32 v86, v72, v81
    v_fmac_f32 v87, v73, v81
    v_fmac_f32 v88, v74, v81
    v_fmac_f32 v89, v75, v81
    v_fmac_f32 v90, v76, v81
    v_fmac_f32 v83, v70, v80
    v_fmac_f32 v84, v71, v80
    buffer_load_dwordx4 v9, s[44:47], s13 offen offset:2048 lds
    v_fmac_f32 v85, v72, v80
    v_fmac_f32 v86, v73, v80
    v_fmac_f32 v87, v74, v80
    v_fmac_f32 v88, v75, v80
    v_fmac_f32 v89, v76, v80
    v_fmac_f32 v90, v77, v80
    v_fmac_f32 v83, v71, v79
    v_fmac_f32 v84, v72, v79
    v_fmac_f32 v85, v73, v79
    buffer_load_dwordx4 v10, s[44:47], s13 offen offset:3072 lds
    v_fmac_f32 v86, v74, v79
    v_fmac_f32 v87, v75, v79
    v_fmac_f32 v88, v76, v79
    v_fmac_f32 v89, v77, v79
    v_fmac_f32 v90, v78, v79
    v_and_b32 v68, 0xffff0000, v43
    v_and_b32 v69, 0xffff0000, v45
    v_and_b32 v70, 0xffff0000, v47
    v_and_b32 v71, 0xffff0000, v49
    s_add_u32 m0, s15, 8192
    s_add_u32 s13, s13, 4096
    buffer_load_dwordx4 v9, s[44:47], s13 offen offset:0 lds
    v_and_b32 v72, 0xffff0000, v51
    v_and_b32 v73, 0xffff0000, v53
    v_and_b32 v74, 0xffff0000, v55
    v_and_b32 v75, 0xffff0000, v57
    v_mul_f32 v83, v83, v68
    v_mul_f32 v84, v84, v69
    v_mul_f32 v85, v85, v70
    v_mul_f32 v86, v86, v71
    v_mul_f32 v87, v87, v72
    buffer_load_dwordx4 v10, s[44:47], s13 offen offset:1024 lds
    v_mul_f32 v88, v88, v73
    v_mul_f32 v89, v89, v74
    v_mul_f32 v90, v90, v75
    v_cvt_pk_bf16_f32 v116, v90, v89
    v_cvt_pk_bf16_f32 v117, v88, v87
    v_cvt_pk_bf16_f32 v118, v86, v85
    v_cvt_pk_bf16_f32 v119, v84, v83
    buffer_load_dword v19, v2, s[56:59], 0 offen sc1
    s_movk_i32 s7, 0x1000
    s_movk_i32 s12, 0x2000
    s_movk_i32 s13, 0x3000
    buffer_store_dwordx4 v[104:107], v18, s[8:11], 0 offen sc1
    buffer_store_dwordx4 v[108:111], v18, s[8:11], s7 offen sc1
    buffer_store_dwordx4 v[112:115], v18, s[8:11], s12 offen sc1
    buffer_store_dwordx4 v[116:119], v18, s[8:11], s13 offen sc1
    s_waitcnt vmcnt(25)
    s_barrier
    s_xor_b32 s14, s95, 9
    s_lshl_b32 s12, s14, 7
    s_add_u32 m0, s15, 40960
    s_add_u32 s12, s12, s96
    buffer_load_dwordx4 v5, s[40:43], s12 offen offset:0 lds
    buffer_load_dwordx4 v6, s[40:43], s12 offen offset:1024 lds
    buffer_load_dwordx4 v7, s[40:43], s12 offen offset:2048 lds
    buffer_load_dwordx4 v8, s[40:43], s12 offen offset:3072 lds
    s_mul_i32 s14, s14, 393216
    s_add_u32 m0, s15, 45056
    s_add_u32 s13, s14, s97
    buffer_load_dwordx4 v9, s[44:47], s13 offen offset:0 lds
    buffer_load_dwordx4 v10, s[44:47], s13 offen offset:1024 lds
    buffer_load_dwordx4 v9, s[44:47], s13 offen offset:2048 lds
    buffer_load_dwordx4 v10, s[44:47], s13 offen offset:3072 lds
    s_add_u32 m0, s15, 49152
    s_add_u32 s13, s13, 4096
    buffer_load_dwordx4 v9, s[44:47], s13 offen offset:0 lds
    buffer_load_dwordx4 v10, s[44:47], s13 offen offset:1024 lds
    s_waitcnt vmcnt(25)
    s_barrier
    s_xor_b32 s14, s95, 10
    s_lshl_b32 s12, s14, 7
    s_add_u32 m0, s15, 81920
    s_add_u32 s12, s12, s96
    buffer_load_dwordx4 v5, s[40:43], s12 offen offset:0 lds
    v_lshrrev_b32 v221, 1, v0
    v_mul_u32_u24 v221, 16704, v221
    v_and_b32 v222, 1, v0
    v_lshl_add_u32 v221, v222, 4, v221
    v_add_u32 v221, s65, v221
    v_subrev_u32 v222, 8, v0
    v_min_u32 v222, 31, v222
    v_lshlrev_b32 v222, 4, v222
    v_add_u32 v222, 4096, v222
    buffer_load_dwordx4 v6, s[40:43], s12 offen offset:1024 lds
    v_add_u32 v222, s66, v222
    v_cmp_gt_u32 vcc, 8, v0
    v_mov_b32 v168, 0
    v_mov_b32 v169, 0
    v_mov_b32 v170, 0
    v_mov_b32 v171, 0
    v_mov_b32 v172, 0
    v_mov_b32 v173, 0
    v_mov_b32 v174, 0
    buffer_load_dwordx4 v7, s[40:43], s12 offen offset:2048 lds
    v_mov_b32 v175, 0
    v_mov_b32 v176, 0
    v_mov_b32 v177, 0
    v_mov_b32 v178, 0
    v_mov_b32 v179, 0
    v_mov_b32 v180, 0
    v_mov_b32 v181, 0
    v_mov_b32 v182, 0
    v_mov_b32 v183, 0
    buffer_load_dwordx4 v8, s[40:43], s12 offen offset:3072 lds
    v_mov_b32 v184, 0
    v_mov_b32 v185, 0
    v_mov_b32 v186, 0
    v_mov_b32 v187, 0
    v_mov_b32 v188, 0
    v_mov_b32 v189, 0
    v_mov_b32 v190, 0
    v_mov_b32 v191, 0
    v_mov_b32 v192, 0
    s_mul_i32 s14, s14, 393216
    s_add_u32 m0, s15, 86016
    s_add_u32 s13, s14, s97
    buffer_load_dwordx4 v9, s[44:47], s13 offen offset:0 lds
    v_mov_b32 v193, 0
    v_mov_b32 v194, 0
    v_mov_b32 v195, 0
    v_mov_b32 v196, 0
    v_mov_b32 v197, 0
    v_mov_b32 v198, 0
    v_mov_b32 v199, 0
    v_cndmask_b32 v221, v222, v221, vcc
    v_and_b32 v222, 3, v0
    buffer_load_dwordx4 v10, s[44:47], s13 offen offset:1024 lds
    v_mul_u32_u24 v223, 16704, v222
    v_lshlrev_b32 v222, 1, v222
    v_sub_u32 v222, v223, v222
    v_add_u32 v222, 30, v222
    v_add_u32 v222, s65, v222
    v_lshrrev_b32 v224, 4, v0
    v_lshl_add_u32 v223, v224, 4, v223
    v_bfe_u32 v225, v0, 2, 2
    v_lshl_add_u32 v223, v225, 3, v223
    buffer_load_dwordx4 v9, s[44:47], s13 offen offset:2048 lds
    v_add_u32 v223, s65, v223
    v_and_b32 v225, 15, v0
    v_lshlrev_b32 v226, 5, v225
    v_lshlrev_b32 v227, 4, v224
    v_sub_u32 v227, v227, v226
    v_lshl_add_u32 v226, v224, 3, v226
    v_add_u32 v227, 480, v227
    v_add_u32 v224, s66, v227
    v_sub_u32 v225, 504, v226
    buffer_load_dwordx4 v10, s[44:47], s13 offen offset:3072 lds
    v_add_u32 v225, s66, v225
    v_mov_b32 v227, 85248
    s_add_u32 m0, s15, 90112
    s_add_u32 s13, s13, 4096
    buffer_load_dwordx4 v9, s[44:47], s13 offen offset:0 lds
    buffer_load_dwordx4 v10, s[44:47], s13 offen offset:1024 lds
    s_waitcnt vmcnt(25)
    s_barrier
    s_xor_b32 s14, s95, 11
    s_lshl_b32 s12, s14, 7
    s_add_u32 m0, s15, 122880
    s_add_u32 s12, s12, s96
    buffer_load_dwordx4 v5, s[40:43], s12 offen offset:0 lds
    buffer_load_dwordx4 v6, s[40:43], s12 offen offset:1024 lds
    buffer_load_dwordx4 v7, s[40:43], s12 offen offset:2048 lds
    buffer_load_dwordx4 v8, s[40:43], s12 offen offset:3072 lds
    s_mul_i32 s14, s14, 393216
    s_add_u32 m0, s15, 126976
    s_add_u32 s13, s14, s97
    buffer_load_dwordx4 v9, s[44:47], s13 offen offset:0 lds
    buffer_load_dwordx4 v10, s[44:47], s13 offen offset:1024 lds
    buffer_load_dwordx4 v9, s[44:47], s13 offen offset:2048 lds
    buffer_load_dwordx4 v10, s[44:47], s13 offen offset:3072 lds
    s_add_u32 m0, s15, 131072
    s_add_u32 s13, s13, 4096
    buffer_load_dwordx4 v9, s[44:47], s13 offen offset:0 lds
    buffer_load_dwordx4 v10, s[44:47], s13 offen offset:1024 lds
    s_waitcnt vmcnt(20)
    s_barrier
    s_xor_b32 s14, s95, 12
    s_lshl_b32 s12, s14, 7
    s_add_u32 m0, s15, 0
    s_add_u32 s12, s12, s96
    buffer_load_dwordx4 v5, s[40:43], s12 offen offset:0 lds
    buffer_load_dwordx4 v6, s[40:43], s12 offen offset:1024 lds
    buffer_load_dwordx4 v7, s[40:43], s12 offen offset:2048 lds
    buffer_load_dwordx4 v8, s[40:43], s12 offen offset:3072 lds
    s_mul_i32 s14, s14, 393216
    s_add_u32 m0, s15, 4096
    s_add_u32 s13, s14, s97
    buffer_load_dwordx4 v9, s[44:47], s13 offen offset:0 lds
    buffer_load_dwordx4 v10, s[44:47], s13 offen offset:1024 lds
    buffer_load_dwordx4 v9, s[44:47], s13 offen offset:2048 lds
    buffer_load_dwordx4 v10, s[44:47], s13 offen offset:3072 lds
    s_add_u32 m0, s15, 8192
    s_add_u32 s13, s13, 4096
    buffer_load_dwordx4 v9, s[44:47], s13 offen offset:0 lds
    buffer_load_dwordx4 v10, s[44:47], s13 offen offset:1024 lds
    v_cmp_le_u32 s[100:101], 16, v19
    s_cmp_eq_u64 s[100:101], -1
    s_cbranch_scc1 INITP_OK
    s_mov_b32 s98, 0
INITP:
    buffer_load_dword v19, v2, s[56:59], 0 offen sc1
    s_waitcnt vmcnt(0)
    v_cmp_le_u32 s[100:101], 16, v19
    s_cmp_eq_u64 s[100:101], -1
    s_cbranch_scc1 INITP_OK
    s_sleep 2
    s_add_u32 s98, s98, 1
    s_cmp_lt_u32 s98, 0x80000
    s_cbranch_scc1 INITP
INITP_OK:
    s_cmp_lg_u32 s6, 0
    s_cbranch_scc1 NOSIGU
    s_and_b32 s7, s2, 15
    s_lshl_b32 s7, s7, 4
    s_lshr_b32 s12, s2, 4
    s_add_u32 s7, s7, s12
    s_lshl_b32 s7, s7, 7
    s_add_u32 s7, s7, 25198592
    s_mov_b64 exec, 1
    v_mov_b32 v11, 1
    buffer_store_dword v11, v2, s[8:11], s7 offen sc1
    s_mov_b64 exec, -1
NOSIGU:
    s_waitcnt vmcnt(20)
    s_barrier
    s_xor_b32 s14, s95, 13
    s_lshl_b32 s12, s14, 7
    s_add_u32 m0, s15, 40960
    s_add_u32 s12, s12, s96
    buffer_load_dwordx4 v5, s[40:43], s12 offen offset:0 lds
    buffer_load_dwordx4 v6, s[40:43], s12 offen offset:1024 lds
    buffer_load_dwordx4 v7, s[40:43], s12 offen offset:2048 lds
    buffer_load_dwordx4 v8, s[40:43], s12 offen offset:3072 lds
    s_mul_i32 s14, s14, 393216
    s_add_u32 m0, s15, 45056
    s_add_u32 s13, s14, s97
    buffer_load_dwordx4 v9, s[44:47], s13 offen offset:0 lds
    buffer_load_dwordx4 v10, s[44:47], s13 offen offset:1024 lds
    buffer_load_dwordx4 v9, s[44:47], s13 offen offset:2048 lds
    buffer_load_dwordx4 v10, s[44:47], s13 offen offset:3072 lds
    s_add_u32 m0, s15, 49152
    s_add_u32 s13, s13, 4096
    buffer_load_dwordx4 v9, s[44:47], s13 offen offset:0 lds
    buffer_load_dwordx4 v10, s[44:47], s13 offen offset:1024 lds
    s_lshr_b32 s7, s2, 4
    s_lshl_b32 s7, s7, 11
    s_add_u32 s67, s7, 25198592
    buffer_load_dword v19, v254, s[8:11], s67 offen sc1
    s_waitcnt vmcnt(21)
    s_barrier
    s_xor_b32 s14, s95, 14
    s_lshl_b32 s12, s14, 7
    s_add_u32 m0, s15, 81920
    s_add_u32 s12, s12, s96
    buffer_load_dwordx4 v5, s[40:43], s12 offen offset:0 lds
    buffer_load_dwordx4 v6, s[40:43], s12 offen offset:1024 lds
    buffer_load_dwordx4 v7, s[40:43], s12 offen offset:2048 lds
    buffer_load_dwordx4 v8, s[40:43], s12 offen offset:3072 lds
    s_mul_i32 s14, s14, 393216
    s_add_u32 m0, s15, 86016
    s_add_u32 s13, s14, s97
    buffer_load_dwordx4 v9, s[44:47], s13 offen offset:0 lds
    buffer_load_dwordx4 v10, s[44:47], s13 offen offset:1024 lds
    buffer_load_dwordx4 v9, s[44:47], s13 offen offset:2048 lds
    buffer_load_dwordx4 v10, s[44:47], s13 offen offset:3072 lds
    s_add_u32 m0, s15, 90112
    s_add_u32 s13, s13, 4096
    buffer_load_dwordx4 v9, s[44:47], s13 offen offset:0 lds
    buffer_load_dwordx4 v10, s[44:47], s13 offen offset:1024 lds
    s_waitcnt vmcnt(21)
    s_barrier
    s_xor_b32 s14, s95, 15
    s_lshl_b32 s12, s14, 7
    s_add_u32 m0, s15, 122880
    s_add_u32 s12, s12, s96
    buffer_load_dwordx4 v5, s[40:43], s12 offen offset:0 lds
    buffer_load_dwordx4 v6, s[40:43], s12 offen offset:1024 lds
    buffer_load_dwordx4 v7, s[40:43], s12 offen offset:2048 lds
    buffer_load_dwordx4 v8, s[40:43], s12 offen offset:3072 lds
    s_mul_i32 s14, s14, 393216
    s_add_u32 m0, s15, 126976
    s_add_u32 s13, s14, s97
    buffer_load_dwordx4 v9, s[44:47], s13 offen offset:0 lds
    buffer_load_dwordx4 v10, s[44:47], s13 offen offset:1024 lds
    buffer_load_dwordx4 v9, s[44:47], s13 offen offset:2048 lds
    buffer_load_dwordx4 v10, s[44:47], s13 offen offset:3072 lds
    s_add_u32 m0, s15, 131072
    s_add_u32 s13, s13, 4096
    buffer_load_dwordx4 v9, s[44:47], s13 offen offset:0 lds
    buffer_load_dwordx4 v10, s[44:47], s13 offen offset:1024 lds
    s_waitcnt vmcnt(21)
    s_barrier
    s_waitcnt vmcnt(10)
    s_barrier
    v_cmp_eq_u32 s[100:101], 1, v19
    s_cmp_eq_u64 s[100:101], -1
    s_cbranch_scc0 NOUT
    s_add_u32 s12, s64, 16777216
    v_min_u32 v203, 31, v0
    v_lshlrev_b32 v203, 7, v203
    buffer_load_dword v204, v203, s[8:11], s12 offen sc1
NOUT:
    buffer_load_dword v19, v254, s[8:11], s67 offen sc1
    v_mov_b32 v208, v121
    v_mov_b32 v209, v122
    v_mov_b32 v210, v123
    v_mov_b32 v211, v124
    ds_write_b128 v205, v[208:211] offset:16736
    v_mov_b32 v212, v129
    v_mov_b32 v213, v130
    v_mov_b32 v214, v131
    v_mov_b32 v215, v132
    ds_write_b128 v205, v[212:215] offset:17760
    v_mov_b32 v208, v137
    v_mov_b32 v209, v138
    v_mov_b32 v210, v139
    v_mov_b32 v211, v140
    ds_write_b128 v205, v[208:211] offset:18784
    v_mov_b32 v212, v145
    v_mov_b32 v213, v146
    v_mov_b32 v214, v147
    v_mov_b32 v215, v148
    ds_write_b128 v205, v[212:215] offset:19808
    ds_write_b128 v205, v[122:125] offset:50144
    ds_write_b128 v205, v[130:133] offset:51168
    ds_write_b128 v205, v[138:141] offset:52192
    ds_write_b128 v205, v[146:149] offset:53216
    v_alignbit_b32 v208, v121, v120, 16
    v_alignbit_b32 v209, v122, v121, 16
    v_alignbit_b32 v210, v123, v122, 16
    v_alignbit_b32 v211, v124, v123, 16
    ds_write_b128 v205, v[208:211] offset:32
    v_alignbit_b32 v212, v129, v128, 16
    v_alignbit_b32 v213, v130, v129, 16
    v_alignbit_b32 v214, v131, v130, 16
    v_alignbit_b32 v215, v132, v131, 16
    ds_write_b128 v205, v[212:215] offset:1056
    v_alignbit_b32 v208, v137, v136, 16
    v_alignbit_b32 v209, v138, v137, 16
    v_alignbit_b32 v210, v139, v138, 16
    v_alignbit_b32 v211, v140, v139, 16
    ds_write_b128 v205, v[208:211] offset:2080
    v_alignbit_b32 v212, v145, v144, 16
    v_alignbit_b32 v213, v146, v145, 16
    v_alignbit_b32 v214, v147, v146, 16
    v_alignbit_b32 v215, v148, v147, 16
    ds_write_b128 v205, v[212:215] offset:3104
    v_alignbit_b32 v208, v122, v121, 16
    v_alignbit_b32 v209, v123, v122, 16
    v_alignbit_b32 v210, v124, v123, 16
    v_alignbit_b32 v211, v125, v124, 16
    ds_write_b128 v205, v[208:211] offset:33440
    v_alignbit_b32 v212, v130, v129, 16
    v_alignbit_b32 v213, v131, v130, 16
    v_alignbit_b32 v214, v132, v131, 16
    v_alignbit_b32 v215, v133, v132, 16
    ds_write_b128 v205, v[212:215] offset:34464
    v_alignbit_b32 v208, v138, v137, 16
    v_alignbit_b32 v209, v139, v138, 16
    v_alignbit_b32 v210, v140, v139, 16
    v_alignbit_b32 v211, v141, v140, 16
    ds_write_b128 v205, v[208:211] offset:35488
    v_alignbit_b32 v212, v146, v145, 16
    v_alignbit_b32 v213, v147, v146, 16
    v_alignbit_b32 v214, v148, v147, 16
    v_alignbit_b32 v215, v149, v148, 16
    ds_write_b128 v205, v[212:215] offset:36512
    s_waitcnt vmcnt(1)
    s_barrier
    ds_write_b128 v221, v[168:171]
    ds_write_b32 v227, v2
    s_add_u32 s12, s64, 16777216
    s_mov_b32 m0, s66
    s_waitcnt vmcnt(0)
    v_cmp_eq_u32 s[100:101], 1, v19
    s_cmp_eq_u64 s[100:101], -1
    s_cbranch_scc1 U_EARLY
    s_waitcnt lgkmcnt(0)
    s_barrier
    s_mov_b32 s98, 0
POLLU:
    buffer_load_dword v19, v254, s[8:11], s67 offen sc1
    s_waitcnt vmcnt(0)
    v_cmp_eq_u32 s[100:101], 1, v19
    s_cmp_eq_u64 s[100:101], -1
    s_cbranch_scc1 POLLU_OK
    s_sleep 2
    s_add_u32 s98, s98, 1
    s_cmp_lt_u32 s98, 0x80000
    s_cbranch_scc1 POLLU
POLLU_OK:
    buffer_load_dwordx4 v1, s[8:11], s12 offen offset:0 sc1 lds
    buffer_load_dwordx4 v1, s[8:11], s12 offen offset:1024 sc1 lds
    buffer_load_dwordx4 v1, s[8:11], s12 offen offset:2048 sc1 lds
    buffer_load_dwordx4 v1, s[8:11], s12 offen offset:3072 sc1 lds
    s_branch U_JOIN
U_EARLY:
    buffer_load_dwordx4 v1, s[8:11], s12 offen offset:0 sc1 lds
    buffer_load_dwordx4 v1, s[8:11], s12 offen offset:1024 sc1 lds
    buffer_load_dwordx4 v1, s[8:11], s12 offen offset:2048 sc1 lds
    buffer_load_dwordx4 v1, s[8:11], s12 offen offset:3072 sc1 lds
    s_waitcnt lgkmcnt(0)
    s_barrier
U_JOIN:
    s_waitcnt vmcnt(4)
    v_lshlrev_b32 v220, 16, v202
    ds_write_b64 v222, v[200:201]
    s_add_u32 s7, s64, 20971520
    v_add_u32 v216, s7, v226
    s_and_b32 s4, s2, 6
    s_lshl_b32 s4, s4, 2
    s_lshr_b32 s5, s2, 6
    s_lshl_b32 s5, s5, 1
    s_or_b32 s4, s4, s5
    s_bfe_u32 s5, s2, 0x10003
    s_or_b32 s4, s4, s5
    s_lshr_b32 s5, s2, 1
    s_xor_b32 s5, s5, s2
    s_and_b32 s5, s5, 1
    s_lshl_b32 s5, s5, 2
    s_bfe_u32 s6, s2, 0x20004
    s_or_b32 s5, s5, s6
    s_lshl_b32 s6, s4, 18
    s_add_u32 s6, s6, 4194304
    s_lshl_b32 s13, s3, 11
    s_add_u32 s12, s6, s13
    s_add_u32 s12, s12, 32768
    s_add_u32 s13, s13, 98304
    s_lshl_b32 s14, s5, 3
    s_add_u32 s14, s14, s3
    s_lshl_b32 s15, s14, 5
    s_add_u32 s15, s15, s4
    s_lshl_b32 s58, s5, 5
    s_add_u32 s58, s58, s4
    s_lshl_b32 s58, s58, 7
    s_add_u32 s58, s58, 25264128
    s_lshl_b32 s57, s2, 7
    s_add_u32 s57, s57, 25231360
    s_cmp_eq_u32 s3, 4
    s_cselect_b32 s57, s57, 0x7fff0000
    s_cselect_b32 s58, s58, 0x7fff0000
    s_lshl_b32 s15, s15, 11
    s_add_u32 s15, s15, 12582912
    v_add_u32 v128, 98304, v1
    v_add_u32 v3, s13, v1
    s_and_b32 s40, s2, 7
    s_lshl_b32 s40, s40, 1
    s_bfe_u32 s41, s2, 0x10003
    s_or_b32 s40, s40, s41
    s_lshr_b32 s41, s2, 4
    s_mov_b32 s44, s32
    s_and_b32 s45, s33, 0xffff
    s_mov_b32 s46, 2097152
    s_mov_b32 s47, 0x00020000
    s_mov_b32 s52, s16
    s_and_b32 s53, s17, 0xffff
    s_mov_b32 s54, 4194304
    s_mov_b32 s55, 0x00020000
    v_lshrrev_b32 v5, 3, v0
    v_and_b32 v6, 7, v0
    v_bfe_u32 v7, v0, 4, 1
    v_lshlrev_b32 v7, 2, v7
    v_xor_b32 v7, v7, v6
    v_lshlrev_b32 v7, 4, v7
    v_lshl_add_u32 v129, v5, 11, v7
    s_lshl_b32 s48, s3, 14
    s_lshl_b32 s49, s41, 7
    s_add_u32 s48, s48, s49
    s_lshl_b32 s49, s3, 10
    s_mov_b32 s43, s49
    s_and_b32 s59, s3, 3
    s_lshl_b32 s50, s40, 2
    s_add_u32 s59, s59, s50
    s_lshl_b32 s59, s59, 1
    s_lshr_b32 s50, s3, 2
    s_add_u32 s59, s59, s50
    s_lshl_b32 s60, s59, 15
    s_add_u32 s60, s60, 12582912
    s_lshr_b32 s59, s40, 1
    s_lshl_b32 s59, s59, 1
    s_add_u32 s59, s59, s50
    s_lshl_b32 s59, s59, 11
    s_add_u32 s59, s59, 25264128
    s_lshr_b32 s50, s2, 4
    s_lshl_b32 s50, s50, 7
    s_lshl_b32 s51, s3, 4
    s_add_u32 s50, s50, s51
    s_and_b32 s51, s2, 15
    s_lshl_b32 s56, s51, 11
    s_add_u32 s56, s56, 25231360
    s_lshl_b32 s51, s51, 6
    v_lshl_add_u32 v5, v5, 1, s50
    v_lshl_add_u32 v6, v6, 3, s51
    v_lshlrev_b32 v132, 1, v5
    v_lshl_add_u32 v132, v6, 12, v132
    v_lshlrev_b32 v133, 1, v6
    v_lshl_add_u32 v134, v5, 11, v133
    v_lshl_add_u32 v133, v5, 12, v133
    s_lshr_b32 s61, s40, 3
    s_lshl_b32 s61, s61, 1
    s_lshl_b32 s61, s61, 2
    v_xor_b32 v131, s61, v0
    v_and_b32 v131, 15, v131
    v_lshlrev_b32 v131, 7, v131
    v_add_u32 v130, s43, v128
    s_and_b32 s63, s61, 8
    s_lshl_b32 s63, 0x11, s63
    s_and_b32 s30, s41, 2
    s_lshl_b32 s30, s30, 11
    s_cmp_lt_u32 s3, 4
    s_cselect_b32 s63, 0x1111, s63
    s_mov_b32 s27, 0x7fff0000
    s_mov_b32 s28, 0x7fff0000
    v_bfe_u32 v5, v0, 2, 1
    v_cmp_eq_u32 vcc, 0, v5
    v_mov_b32 v6, 0x3f803f80
    v_and_b32 v5, 1, v0
    v_cndmask_b32 v124, 0, v6, vcc
    v_xor_b32 v126, v6, v124
    v_mov_b32 v125, v124
    v_mov_b32 v127, v126
    v_mul_u32_u24 v15, 0xaaaa, v5
    v_add_u32 v15, 0x4444, v15
    v_mov_b32 v88, 0
    v_mov_b32 v89, 0
    v_mov_b32 v90, 0
    v_mov_b32 v91, 0
    ds_read_b64 v[16:17], v223 offset:0
    ds_read_b64 v[18:19], v223 offset:8
    ds_read_b64 v[20:21], v223 offset:512
    ds_read_b64 v[22:23], v223 offset:520
    ds_read_b64 v[24:25], v223 offset:1024
    ds_read_b64 v[26:27], v223 offset:1032
    ds_read_b64 v[28:29], v223 offset:1536
    ds_read_b64 v[30:31], v223 offset:1544
    ds_read_b64 v[32:33], v223 offset:2048
    ds_read_b64 v[34:35], v223 offset:2056
    ds_read_b64 v[36:37], v223 offset:2560
    ds_read_b64 v[38:39], v223 offset:2568
    ds_read_b64 v[40:41], v223 offset:3072
    ds_read_b64 v[42:43], v223 offset:3080
    ds_read_b64 v[44:45], v223 offset:3584
    ds_read_b64 v[46:47], v223 offset:3592
    s_waitcnt vmcnt(0)
    ds_read_b128 v[48:51], v224 offset:3584
    ds_read_b128 v[52:55], v224 offset:3072
    ds_read_b128 v[56:59], v224 offset:2560
    ds_read_b128 v[60:63], v224 offset:2048
    ds_read_b128 v[64:67], v224 offset:1536
    ds_read_b128 v[68:71], v224 offset:1024
    ds_read_b128 v[72:75], v224 offset:512
    ds_read_b128 v[76:79], v224 offset:0
    s_mov_b32 s7, 0
CONV_LOOP:
    s_waitcnt lgkmcnt(0)
    v_mfma_f32_16x16x32_bf16 v[168:171], v[16:19], v[48:51], v[168:171]
    ds_read_b128 v[136:139], v224 offset:3648
    v_mfma_f32_16x16x32_bf16 v[172:175], v[16:19], v[52:55], v[172:175]
    ds_read_b128 v[140:143], v224 offset:3136
    v_mfma_f32_16x16x32_bf16 v[176:179], v[16:19], v[56:59], v[176:179]
    ds_read_b128 v[144:147], v224 offset:2624
    v_mfma_f32_16x16x32_bf16 v[180:183], v[16:19], v[60:63], v[180:183]
    ds_read_b128 v[148:151], v224 offset:2112
    v_mfma_f32_16x16x32_bf16 v[184:187], v[16:19], v[64:67], v[184:187]
    ds_read_b128 v[152:155], v224 offset:1600
    v_mfma_f32_16x16x32_bf16 v[188:191], v[16:19], v[68:71], v[188:191]
    ds_read_b128 v[156:159], v224 offset:1088
    v_mfma_f32_16x16x32_bf16 v[192:195], v[16:19], v[72:75], v[192:195]
    ds_read_b128 v[160:163], v224 offset:576
    v_mfma_f32_16x16x32_bf16 v[196:199], v[16:19], v[76:79], v[196:199]
    ds_read_b128 v[164:167], v224 offset:64
    v_mfma_f32_16x16x32_bf16 v[172:175], v[20:23], v[48:51], v[172:175]
    ds_read_b64 v[92:93], v223 offset:64
    v_mfma_f32_16x16x32_bf16 v[176:179], v[20:23], v[52:55], v[176:179]
    ds_read_b64 v[94:95], v223 offset:72
    v_mfma_f32_16x16x32_bf16 v[180:183], v[20:23], v[56:59], v[180:183]
    ds_read_b64 v[96:97], v223 offset:576
    v_mfma_f32_16x16x32_bf16 v[184:187], v[20:23], v[60:63], v[184:187]
    ds_read_b64 v[98:99], v223 offset:584
    v_mfma_f32_16x16x32_bf16 v[188:191], v[20:23], v[64:67], v[188:191]
    ds_read_b64 v[100:101], v223 offset:1088
    v_mfma_f32_16x16x32_bf16 v[192:195], v[20:23], v[68:71], v[192:195]
    ds_read_b64 v[102:103], v223 offset:1096
    v_mfma_f32_16x16x32_bf16 v[196:199], v[20:23], v[72:75], v[196:199]
    ds_read_b64 v[104:105], v223 offset:1600
    v_mfma_f32_16x16x32_bf16 v[176:179], v[24:27], v[48:51], v[176:179]
    ds_read_b64 v[106:107], v223 offset:1608
    v_mfma_f32_16x16x32_bf16 v[180:183], v[24:27], v[52:55], v[180:183]
    ds_read_b64 v[108:109], v223 offset:2112
    v_mfma_f32_16x16x32_bf16 v[184:187], v[24:27], v[56:59], v[184:187]
    ds_read_b64 v[110:111], v223 offset:2120
    v_mfma_f32_16x16x32_bf16 v[188:191], v[24:27], v[60:63], v[188:191]
    ds_read_b64 v[112:113], v223 offset:2624
    v_mfma_f32_16x16x32_bf16 v[192:195], v[24:27], v[64:67], v[192:195]
    ds_read_b64 v[114:115], v223 offset:2632
    v_mfma_f32_16x16x32_bf16 v[196:199], v[24:27], v[68:71], v[196:199]
    ds_read_b64 v[116:117], v223 offset:3136
    v_mfma_f32_16x16x32_bf16 v[180:183], v[28:31], v[48:51], v[180:183]
    ds_read_b64 v[118:119], v223 offset:3144
    v_mfma_f32_16x16x32_bf16 v[184:187], v[28:31], v[52:55], v[184:187]
    ds_read_b64 v[120:121], v223 offset:3648
    v_mfma_f32_16x16x32_bf16 v[188:191], v[28:31], v[56:59], v[188:191]
    ds_read_b64 v[122:123], v223 offset:3656
    v_mfma_f32_16x16x32_bf16 v[192:195], v[28:31], v[60:63], v[192:195]
    v_mfma_f32_16x16x32_bf16 v[196:199], v[28:31], v[64:67], v[196:199]
    v_mfma_f32_16x16x32_bf16 v[184:187], v[32:35], v[48:51], v[184:187]
    v_mfma_f32_16x16x32_bf16 v[188:191], v[32:35], v[52:55], v[188:191]
    v_mfma_f32_16x16x32_bf16 v[192:195], v[32:35], v[56:59], v[192:195]
    v_mfma_f32_16x16x32_bf16 v[196:199], v[32:35], v[60:63], v[196:199]
    v_mfma_f32_16x16x32_bf16 v[188:191], v[36:39], v[48:51], v[188:191]
    v_mfma_f32_16x16x32_bf16 v[192:195], v[36:39], v[52:55], v[192:195]
    v_mfma_f32_16x16x32_bf16 v[196:199], v[36:39], v[56:59], v[196:199]
    v_mfma_f32_16x16x32_bf16 v[192:195], v[40:43], v[48:51], v[192:195]
    v_mfma_f32_16x16x32_bf16 v[196:199], v[40:43], v[52:55], v[196:199]
    v_mfma_f32_16x16x32_bf16 v[196:199], v[44:47], v[48:51], v[196:199]
    s_waitcnt lgkmcnt(0)
    v_mfma_f32_16x16x32_bf16 v[168:171], v[92:95], v[136:139], v[168:171]
    ds_read_b128 v[48:51], v224 offset:3712
    v_mfma_f32_16x16x32_bf16 v[172:175], v[92:95], v[140:143], v[172:175]
    ds_read_b128 v[52:55], v224 offset:3200
    v_mfma_f32_16x16x32_bf16 v[176:179], v[92:95], v[144:147], v[176:179]
    ds_read_b128 v[56:59], v224 offset:2688
    v_mfma_f32_16x16x32_bf16 v[180:183], v[92:95], v[148:151], v[180:183]
    ds_read_b128 v[60:63], v224 offset:2176
    v_mfma_f32_16x16x32_bf16 v[184:187], v[92:95], v[152:155], v[184:187]
    ds_read_b128 v[64:67], v224 offset:1664
    v_mfma_f32_16x16x32_bf16 v[188:191], v[92:95], v[156:159], v[188:191]
    ds_read_b128 v[68:71], v224 offset:1152
    v_mfma_f32_16x16x32_bf16 v[192:195], v[92:95], v[160:163], v[192:195]
    ds_read_b128 v[72:75], v224 offset:640
    v_mfma_f32_16x16x32_bf16 v[196:199], v[92:95], v[164:167], v[196:199]
    ds_read_b128 v[76:79], v224 offset:128
    v_mfma_f32_16x16x32_bf16 v[172:175], v[96:99], v[136:139], v[172:175]
    ds_read_b64 v[16:17], v223 offset:128
    v_mfma_f32_16x16x32_bf16 v[176:179], v[96:99], v[140:143], v[176:179]
    ds_read_b64 v[18:19], v223 offset:136
    v_mfma_f32_16x16x32_bf16 v[180:183], v[96:99], v[144:147], v[180:183]
    ds_read_b64 v[20:21], v223 offset:640
    v_mfma_f32_16x16x32_bf16 v[184:187], v[96:99], v[148:151], v[184:187]
    ds_read_b64 v[22:23], v223 offset:648
    v_mfma_f32_16x16x32_bf16 v[188:191], v[96:99], v[152:155], v[188:191]
    ds_read_b64 v[24:25], v223 offset:1152
    v_mfma_f32_16x16x32_bf16 v[192:195], v[96:99], v[156:159], v[192:195]
    ds_read_b64 v[26:27], v223 offset:1160
    v_mfma_f32_16x16x32_bf16 v[196:199], v[96:99], v[160:163], v[196:199]
    ds_read_b64 v[28:29], v223 offset:1664
    v_mfma_f32_16x16x32_bf16 v[176:179], v[100:103], v[136:139], v[176:179]
    ds_read_b64 v[30:31], v223 offset:1672
    v_mfma_f32_16x16x32_bf16 v[180:183], v[100:103], v[140:143], v[180:183]
    ds_read_b64 v[32:33], v223 offset:2176
    v_mfma_f32_16x16x32_bf16 v[184:187], v[100:103], v[144:147], v[184:187]
    ds_read_b64 v[34:35], v223 offset:2184
    v_mfma_f32_16x16x32_bf16 v[188:191], v[100:103], v[148:151], v[188:191]
    ds_read_b64 v[36:37], v223 offset:2688
    v_mfma_f32_16x16x32_bf16 v[192:195], v[100:103], v[152:155], v[192:195]
    ds_read_b64 v[38:39], v223 offset:2696
    v_mfma_f32_16x16x32_bf16 v[196:199], v[100:103], v[156:159], v[196:199]
    ds_read_b64 v[40:41], v223 offset:3200
    v_mfma_f32_16x16x32_bf16 v[180:183], v[104:107], v[136:139], v[180:183]
    ds_read_b64 v[42:43], v223 offset:3208
    v_mfma_f32_16x16x32_bf16 v[184:187], v[104:107], v[140:143], v[184:187]
    ds_read_b64 v[44:45], v223 offset:3712
    v_mfma_f32_16x16x32_bf16 v[188:191], v[104:107], v[144:147], v[188:191]
    ds_read_b64 v[46:47], v223 offset:3720
    v_mfma_f32_16x16x32_bf16 v[192:195], v[104:107], v[148:151], v[192:195]
    v_add_u32 v223, 128, v223
    v_mfma_f32_16x16x32_bf16 v[196:199], v[104:107], v[152:155], v[196:199]
    v_add_u32 v224, 128, v224
    v_mfma_f32_16x16x32_bf16 v[184:187], v[108:111], v[136:139], v[184:187]
    s_add_u32 s7, s7, 1
    v_mfma_f32_16x16x32_bf16 v[188:191], v[108:111], v[140:143], v[188:191]
    s_cmp_lt_u32 s7, 3
    v_mfma_f32_16x16x32_bf16 v[192:195], v[108:111], v[144:147], v[192:195]
    v_mfma_f32_16x16x32_bf16 v[196:199], v[108:111], v[148:151], v[196:199]
    v_mfma_f32_16x16x32_bf16 v[188:191], v[112:115], v[136:139], v[188:191]
    v_mfma_f32_16x16x32_bf16 v[192:195], v[112:115], v[140:143], v[192:195]
    v_mfma_f32_16x16x32_bf16 v[196:199], v[112:115], v[144:147], v[196:199]
    v_mfma_f32_16x16x32_bf16 v[192:195], v[116:119], v[136:139], v[192:195]
    v_mfma_f32_16x16x32_bf16 v[196:199], v[116:119], v[140:143], v[196:199]
    v_mfma_f32_16x16x32_bf16 v[196:199], v[120:123], v[136:139], v[196:199]
    s_cbranch_scc1 CONV_LOOP
    s_waitcnt lgkmcnt(0)
    v_mfma_f32_16x16x32_bf16 v[168:171], v[16:19], v[48:51], v[168:171]
    ds_read_b128 v[136:139], v224 offset:3648
    v_mfma_f32_16x16x32_bf16 v[172:175], v[16:19], v[52:55], v[172:175]
    ds_read_b128 v[140:143], v224 offset:3136
    v_mfma_f32_16x16x32_bf16 v[176:179], v[16:19], v[56:59], v[176:179]
    ds_read_b128 v[144:147], v224 offset:2624
    v_mfma_f32_16x16x32_bf16 v[180:183], v[16:19], v[60:63], v[180:183]
    ds_read_b128 v[148:151], v224 offset:2112
    v_mfma_f32_16x16x32_bf16 v[184:187], v[16:19], v[64:67], v[184:187]
    ds_read_b128 v[152:155], v224 offset:1600
    v_mfma_f32_16x16x32_bf16 v[188:191], v[16:19], v[68:71], v[188:191]
    ds_read_b128 v[156:159], v224 offset:1088
    v_mfma_f32_16x16x32_bf16 v[192:195], v[16:19], v[72:75], v[192:195]
    ds_read_b128 v[160:163], v224 offset:576
    v_mfma_f32_16x16x32_bf16 v[196:199], v[16:19], v[76:79], v[196:199]
    ds_read_b128 v[164:167], v224 offset:64
    v_mfma_f32_16x16x32_bf16 v[172:175], v[20:23], v[48:51], v[172:175]
    ds_read_b64 v[92:93], v223 offset:64
    v_mfma_f32_16x16x32_bf16 v[176:179], v[20:23], v[52:55], v[176:179]
    ds_read_b64 v[94:95], v223 offset:72
    v_mfma_f32_16x16x32_bf16 v[180:183], v[20:23], v[56:59], v[180:183]
    ds_read_b64 v[96:97], v223 offset:576
    v_mfma_f32_16x16x32_bf16 v[184:187], v[20:23], v[60:63], v[184:187]
    ds_read_b64 v[98:99], v223 offset:584
    v_mfma_f32_16x16x32_bf16 v[188:191], v[20:23], v[64:67], v[188:191]
    ds_read_b64 v[100:101], v223 offset:1088
    v_mfma_f32_16x16x32_bf16 v[192:195], v[20:23], v[68:71], v[192:195]
    ds_read_b64 v[102:103], v223 offset:1096
    v_mfma_f32_16x16x32_bf16 v[196:199], v[20:23], v[72:75], v[196:199]
    ds_read_b64 v[104:105], v223 offset:1600
    v_mfma_f32_16x16x32_bf16 v[176:179], v[24:27], v[48:51], v[176:179]
    ds_read_b64 v[106:107], v223 offset:1608
    v_mfma_f32_16x16x32_bf16 v[180:183], v[24:27], v[52:55], v[180:183]
    ds_read_b64 v[108:109], v223 offset:2112
    v_mfma_f32_16x16x32_bf16 v[184:187], v[24:27], v[56:59], v[184:187]
    ds_read_b64 v[110:111], v223 offset:2120
    v_mfma_f32_16x16x32_bf16 v[188:191], v[24:27], v[60:63], v[188:191]
    ds_read_b64 v[112:113], v223 offset:2624
    v_mfma_f32_16x16x32_bf16 v[192:195], v[24:27], v[64:67], v[192:195]
    ds_read_b64 v[114:115], v223 offset:2632
    v_mfma_f32_16x16x32_bf16 v[196:199], v[24:27], v[68:71], v[196:199]
    ds_read_b64 v[116:117], v223 offset:3136
    v_mfma_f32_16x16x32_bf16 v[180:183], v[28:31], v[48:51], v[180:183]
    ds_read_b64 v[118:119], v223 offset:3144
    v_mfma_f32_16x16x32_bf16 v[184:187], v[28:31], v[52:55], v[184:187]
    ds_read_b64 v[120:121], v223 offset:3648
    v_mfma_f32_16x16x32_bf16 v[188:191], v[28:31], v[56:59], v[188:191]
    ds_read_b64 v[122:123], v223 offset:3656
    v_mfma_f32_16x16x32_bf16 v[192:195], v[28:31], v[60:63], v[192:195]
    v_mfma_f32_16x16x32_bf16 v[196:199], v[28:31], v[64:67], v[196:199]
    v_mfma_f32_16x16x32_bf16 v[184:187], v[32:35], v[48:51], v[184:187]
    v_mfma_f32_16x16x32_bf16 v[188:191], v[32:35], v[52:55], v[188:191]
    v_mfma_f32_16x16x32_bf16 v[192:195], v[32:35], v[56:59], v[192:195]
    v_mfma_f32_16x16x32_bf16 v[196:199], v[32:35], v[60:63], v[196:199]
    v_mfma_f32_16x16x32_bf16 v[188:191], v[36:39], v[48:51], v[188:191]
    v_mfma_f32_16x16x32_bf16 v[192:195], v[36:39], v[52:55], v[192:195]
    v_mfma_f32_16x16x32_bf16 v[196:199], v[36:39], v[56:59], v[196:199]
    v_mfma_f32_16x16x32_bf16 v[192:195], v[40:43], v[48:51], v[192:195]
    v_mfma_f32_16x16x32_bf16 v[196:199], v[40:43], v[52:55], v[196:199]
    v_mfma_f32_16x16x32_bf16 v[196:199], v[44:47], v[48:51], v[196:199]
    ds_read_b64 v[16:17], v225 offset:3584
    ds_read_b64 v[18:19], v225 offset:3072
    ds_read_b64 v[20:21], v225 offset:2560
    ds_read_b64 v[22:23], v225 offset:2048
    ds_read_b64 v[24:25], v225 offset:1536
    ds_read_b64 v[26:27], v225 offset:1024
    ds_read_b64 v[28:29], v225 offset:512
    ds_read_b64 v[30:31], v225 offset:0
    s_waitcnt lgkmcnt(8)
    v_mfma_f32_16x16x32_bf16 v[168:171], v[92:95], v[136:139], v[168:171]
    v_mfma_f32_16x16x32_bf16 v[172:175], v[92:95], v[140:143], v[172:175]
    v_mfma_f32_16x16x32_bf16 v[172:175], v[96:99], v[136:139], v[172:175]
    v_mfma_f32_16x16x32_bf16 v[176:179], v[92:95], v[144:147], v[176:179]
    v_mfma_f32_16x16x32_bf16 v[176:179], v[96:99], v[140:143], v[176:179]
    v_mfma_f32_16x16x32_bf16 v[176:179], v[100:103], v[136:139], v[176:179]
    s_waitcnt lgkmcnt(0)
    v_mfma_f32_16x16x32_bf16 v[180:183], v[92:95], v[148:151], v[180:183]
    v_and_b32 v48, 0xffff0000, v17
    v_lshlrev_b32 v49, 16, v17
    v_mfma_f32_16x16x32_bf16 v[180:183], v[96:99], v[144:147], v[180:183]
    v_and_b32 v50, 0xffff0000, v16
    v_lshlrev_b32 v51, 16, v16
    v_mfma_f32_16x16x32_bf16 v[180:183], v[100:103], v[140:143], v[180:183]
    v_fmac_f32 v168, v48, v220
    v_fmac_f32 v169, v49, v220
    v_mfma_f32_16x16x32_bf16 v[180:183], v[104:107], v[136:139], v[180:183]
    v_fmac_f32 v170, v50, v220
    v_fmac_f32 v171, v51, v220
    v_mfma_f32_16x16x32_bf16 v[184:187], v[92:95], v[152:155], v[184:187]
    v_cvt_pk_bf16_f32 v200, v168, v169
    v_cvt_pk_bf16_f32 v201, v170, v171
    v_mfma_f32_16x16x32_bf16 v[184:187], v[96:99], v[148:151], v[184:187]
    v_and_b32 v52, 0xffff0000, v19
    v_lshlrev_b32 v53, 16, v19
    v_mfma_f32_16x16x32_bf16 v[184:187], v[100:103], v[144:147], v[184:187]
    v_and_b32 v54, 0xffff0000, v18
    v_lshlrev_b32 v55, 16, v18
    v_mfma_f32_16x16x32_bf16 v[184:187], v[104:107], v[140:143], v[184:187]
    v_fmac_f32 v172, v52, v220
    v_fmac_f32 v173, v53, v220
    v_mfma_f32_16x16x32_bf16 v[184:187], v[108:111], v[136:139], v[184:187]
    v_fmac_f32 v174, v54, v220
    v_fmac_f32 v175, v55, v220
    v_mfma_f32_16x16x32_bf16 v[188:191], v[92:95], v[156:159], v[188:191]
    v_cvt_pk_bf16_f32 v202, v172, v173
    v_cvt_pk_bf16_f32 v203, v174, v175
    v_mfma_f32_16x16x32_bf16 v[188:191], v[96:99], v[152:155], v[188:191]
    v_and_b32 v48, 0xffff0000, v21
    v_lshlrev_b32 v49, 16, v21
    v_mfma_f32_16x16x32_bf16 v[188:191], v[100:103], v[148:151], v[188:191]
    v_and_b32 v50, 0xffff0000, v20
    v_lshlrev_b32 v51, 16, v20
    v_mfma_f32_16x16x32_bf16 v[188:191], v[104:107], v[144:147], v[188:191]
    v_fmac_f32 v176, v48, v220
    v_fmac_f32 v177, v49, v220
    v_mfma_f32_16x16x32_bf16 v[188:191], v[108:111], v[140:143], v[188:191]
    v_fmac_f32 v178, v50, v220
    v_fmac_f32 v179, v51, v220
    v_mfma_f32_16x16x32_bf16 v[188:191], v[112:115], v[136:139], v[188:191]
    v_cvt_pk_bf16_f32 v204, v176, v177
    v_cvt_pk_bf16_f32 v205, v178, v179
    v_mfma_f32_16x16x32_bf16 v[192:195], v[92:95], v[160:163], v[192:195]
    v_and_b32 v52, 0xffff0000, v23
    v_lshlrev_b32 v53, 16, v23
    v_mfma_f32_16x16x32_bf16 v[192:195], v[96:99], v[156:159], v[192:195]
    v_and_b32 v54, 0xffff0000, v22
    v_lshlrev_b32 v55, 16, v22
    v_mfma_f32_16x16x32_bf16 v[192:195], v[100:103], v[152:155], v[192:195]
    v_fmac_f32 v180, v52, v220
    v_fmac_f32 v181, v53, v220
    v_mfma_f32_16x16x32_bf16 v[192:195], v[104:107], v[148:151], v[192:195]
    v_fmac_f32 v182, v54, v220
    v_fmac_f32 v183, v55, v220
    v_mfma_f32_16x16x32_bf16 v[192:195], v[108:111], v[144:147], v[192:195]
    v_cvt_pk_bf16_f32 v206, v180, v181
    v_cvt_pk_bf16_f32 v207, v182, v183
    v_mfma_f32_16x16x32_bf16 v[192:195], v[112:115], v[140:143], v[192:195]
    v_and_b32 v48, 0xffff0000, v25
    v_lshlrev_b32 v49, 16, v25
    v_mfma_f32_16x16x32_bf16 v[192:195], v[116:119], v[136:139], v[192:195]
    v_and_b32 v50, 0xffff0000, v24
    v_lshlrev_b32 v51, 16, v24
    v_mfma_f32_16x16x32_bf16 v[196:199], v[92:95], v[164:167], v[196:199]
    v_fmac_f32 v184, v48, v220
    v_fmac_f32 v185, v49, v220
    v_mfma_f32_16x16x32_bf16 v[196:199], v[96:99], v[160:163], v[196:199]
    v_fmac_f32 v186, v50, v220
    v_fmac_f32 v187, v51, v220
    v_mfma_f32_16x16x32_bf16 v[196:199], v[100:103], v[156:159], v[196:199]
    v_cvt_pk_bf16_f32 v208, v184, v185
    v_cvt_pk_bf16_f32 v209, v186, v187
    v_mfma_f32_16x16x32_bf16 v[196:199], v[104:107], v[152:155], v[196:199]
    v_and_b32 v52, 0xffff0000, v27
    v_lshlrev_b32 v53, 16, v27
    v_mfma_f32_16x16x32_bf16 v[196:199], v[108:111], v[148:151], v[196:199]
    v_and_b32 v54, 0xffff0000, v26
    v_lshlrev_b32 v55, 16, v26
    v_mfma_f32_16x16x32_bf16 v[196:199], v[112:115], v[144:147], v[196:199]
    v_fmac_f32 v188, v52, v220
    v_fmac_f32 v189, v53, v220
    v_mfma_f32_16x16x32_bf16 v[196:199], v[116:119], v[140:143], v[196:199]
    v_fmac_f32 v190, v54, v220
    v_fmac_f32 v191, v55, v220
    v_mfma_f32_16x16x32_bf16 v[196:199], v[120:123], v[136:139], v[196:199]
    v_cvt_pk_bf16_f32 v210, v188, v189
    v_cvt_pk_bf16_f32 v211, v190, v191
    v_and_b32 v48, 0xffff0000, v29
    v_lshlrev_b32 v49, 16, v29
    v_and_b32 v50, 0xffff0000, v28
    v_lshlrev_b32 v51, 16, v28
    v_fmac_f32 v192, v48, v220
    v_fmac_f32 v193, v49, v220
    v_fmac_f32 v194, v50, v220
    v_fmac_f32 v195, v51, v220
    v_cvt_pk_bf16_f32 v212, v192, v193
    v_cvt_pk_bf16_f32 v213, v194, v195
    v_and_b32 v52, 0xffff0000, v31
    v_lshlrev_b32 v53, 16, v31
    v_and_b32 v54, 0xffff0000, v30
    v_lshlrev_b32 v55, 16, v30
    v_fmac_f32 v196, v52, v220
    v_fmac_f32 v197, v53, v220
    v_fmac_f32 v198, v54, v220
    v_fmac_f32 v199, v55, v220
    v_cvt_pk_bf16_f32 v214, v196, v197
    v_cvt_pk_bf16_f32 v215, v198, v199
    s_branch P2_JOIN
P1_COMPUTE:
    s_lshr_b32 s6, s3, 1
    s_and_b32 s7, s3, 1
    v_and_b32 v6, 31, v0
    v_lshrrev_b32 v3, 5, v0
    v_bfe_u32 v4, v0, 1, 3
    v_xor_b32 v4, v4, v3
    v_lshlrev_b32 v4, 4, v4
    v_lshl_add_u32 v4, v6, 7, v4
    s_mul_i32 s12, s6, 20480
    v_add_u32 v4, s12, v4
    v_mov_b32 v160, v4
    v_add_u32 v164, 81920, v160
    v_xor_b32 v161, 32, v4
    v_add_u32 v165, 81920, v161
    v_xor_b32 v162, 64, v4
    v_add_u32 v166, 81920, v162
    v_xor_b32 v163, 96, v4
    v_add_u32 v167, 81920, v163
    v_bfe_u32 v5, v0, 2, 2
    v_lshlrev_b32 v6, 7, v5
    v_lshl_add_u32 v6, v3, 10, v6
    v_bfe_u32 v7, v0, 3, 1
    v_xor_b32 v7, s7, v7
    v_lshl_add_u32 v6, v7, 6, v6
    v_bfe_u32 v7, v0, 4, 1
    v_lshl_add_u32 v6, v7, 5, v6
    v_and_b32 v7, 3, v0
    v_lshl_add_u32 v168, v7, 3, v6
    v_add_u32 v169, 40960, v168
    v_add_u32 v170, 81920, v168
    v_add_u32 v171, 122880, v168
    s_lshl_b32 s12, s5, 1
    s_add_u32 s12, s12, s7
    s_lshl_b32 s7, s5, 4
    s_add_u32 s7, s7, s4
    s_lshl_b32 s7, s7, 7
    s_add_u32 s7, s7, 25165824
    s_lshl_b32 s12, s12, 6
    s_lshl_b32 s13, s4, 2
    s_add_u32 s12, s12, s13
    s_lshl_b32 s13, s6, 1
    s_add_u32 s12, s12, s13
    s_lshl_b32 s13, s12, 11
    s_lshl_b32 s14, s12, 12
    s_add_u32 s14, s14, 4194304
    s_add_u32 s15, s14, 4096
    s_and_b32 s12, s4, 1
    s_lshl_b32 s42, s12, 13
    s_lshl_b32 s43, s6, 12
    s_add_u32 s42, s42, s43
    s_add_u32 s42, s42, 147456
    s_sub_u32 s43, s42, 16384
    s_and_b32 s44, s3, 1
    s_cmp_eq_u32 s44, s12
    s_cselect_b32 s42, s42, s43
    s_cselect_b32 s13, 0x7fff0000, s13
    v_add_u32 v10, s42, v1
    s_mov_b32 s12, 0x3e8293ee
    s_waitcnt lgkmcnt(0)
    s_mov_b32 s8, s38
    s_and_b32 s9, s39, 0xffff
    s_mov_b32 s10, 25296896
    s_mov_b32 s11, 0x00020000
    s_lshl_b32 s42, s3, 4
    s_or_b32 s42, s42, s2
    s_cmp_ge_u32 s42, 16
    s_cbranch_scc1 NOINIT
    s_mov_b32 s56, s36
    s_and_b32 s57, s37, 0xffff
    s_mov_b32 s58, 256
    s_mov_b32 s59, 0x00020000
    v_lshlrev_b32 v8, 7, v0
    s_lshl_b32 s42, s2, 13
    s_add_u32 s42, s42, 25165824
    buffer_store_dword v2, v8, s[8:11], s42 offen sc1
    v_mov_b32 v9, 1
    s_waitcnt vmcnt(0)
    s_mov_b64 exec, 1
    buffer_atomic_add v9, v2, s[56:59], 0 offen
    s_mov_b64 exec, -1
NOINIT:
    v_mov_b32 v64, 0
    v_mov_b32 v65, 0
    v_mov_b32 v66, 0
    v_mov_b32 v67, 0
    v_mov_b32 v68, 0
    v_mov_b32 v69, 0
    v_mov_b32 v70, 0
    v_mov_b32 v71, 0
    v_mov_b32 v72, 0
    v_mov_b32 v73, 0
    v_mov_b32 v74, 0
    v_mov_b32 v75, 0
    v_mov_b32 v76, 0
    v_mov_b32 v77, 0
    v_mov_b32 v78, 0
    v_mov_b32 v79, 0
    v_mov_b32 v80, 0
    v_mov_b32 v81, 0
    v_mov_b32 v82, 0
    v_mov_b32 v83, 0
    v_mov_b32 v84, 0
    v_mov_b32 v85, 0
    v_mov_b32 v86, 0
    v_mov_b32 v87, 0
    v_mov_b32 v88, 0
    v_mov_b32 v89, 0
    v_mov_b32 v90, 0
    v_mov_b32 v91, 0
    v_mov_b32 v92, 0
    v_mov_b32 v93, 0
    v_mov_b32 v94, 0
    v_mov_b32 v95, 0
    v_mov_b32 v96, 0
    v_mov_b32 v97, 0
    v_mov_b32 v98, 0
    v_mov_b32 v99, 0
    v_mov_b32 v100, 0
    v_mov_b32 v101, 0
    v_mov_b32 v102, 0
    v_mov_b32 v103, 0
    v_mov_b32 v104, 0
    v_mov_b32 v105, 0
    v_mov_b32 v106, 0
    v_mov_b32 v107, 0
    v_mov_b32 v108, 0
    v_mov_b32 v109, 0
    v_mov_b32 v110, 0
    v_mov_b32 v111, 0
    v_mov_b32 v112, 0
    v_mov_b32 v113, 0
    v_mov_b32 v114, 0
    v_mov_b32 v115, 0
    v_mov_b32 v116, 0
    v_mov_b32 v117, 0
    v_mov_b32 v118, 0
    v_mov_b32 v119, 0
    v_mov_b32 v120, 0
    v_mov_b32 v121, 0
    v_mov_b32 v122, 0
    v_mov_b32 v123, 0
    v_mov_b32 v124, 0
    v_mov_b32 v125, 0
    v_mov_b32 v126, 0
    v_mov_b32 v127, 0
    v_mov_b32 v128, 0
    v_mov_b32 v129, 0
    v_mov_b32 v130, 0
    v_mov_b32 v131, 0
    v_mov_b32 v132, 0
    v_mov_b32 v133, 0
    v_mov_b32 v134, 0
    v_mov_b32 v135, 0
    v_mov_b32 v136, 0
    v_mov_b32 v137, 0
    v_mov_b32 v138, 0
    v_mov_b32 v139, 0
    v_mov_b32 v140, 0
    v_mov_b32 v141, 0
    v_mov_b32 v142, 0
    v_mov_b32 v143, 0
    v_mov_b32 v144, 0
    v_mov_b32 v145, 0
    v_mov_b32 v146, 0
    v_mov_b32 v147, 0
    v_mov_b32 v148, 0
    v_mov_b32 v149, 0
    v_mov_b32 v150, 0
    v_mov_b32 v151, 0
    v_mov_b32 v152, 0
    v_mov_b32 v153, 0
    v_mov_b32 v154, 0
    v_mov_b32 v155, 0
    v_mov_b32 v156, 0
    v_mov_b32 v157, 0
    v_mov_b32 v158, 0
    v_mov_b32 v159, 0
    s_mov_b32 s6, 0
    s_barrier
    ds_read_b128 v[16:19], v160 offset:0
    ds_read_b64_tr_b16 v[24:25], v168 offset:4096
    ds_read_b64_tr_b16 v[26:27], v168 offset:4608
    ds_read_b128 v[20:23], v160 offset:10240
    ds_read_b64_tr_b16 v[28:29], v168 offset:6144
    ds_read_b64_tr_b16 v[30:31], v168 offset:6656
    ds_read_b64_tr_b16 v[32:33], v168 offset:8192
    ds_read_b64_tr_b16 v[34:35], v168 offset:8704
P1_LOOP:
    s_waitcnt lgkmcnt(0)
    v_mfma_f32_32x32x16_bf16 v[64:79], v[24:27], v[16:19], v[64:79]
    ds_read_b128 v[40:43], v161 offset:0
    ds_read_b64_tr_b16 v[48:49], v168 offset:14336
    ds_read_b64_tr_b16 v[50:51], v168 offset:14848
    v_mfma_f32_32x32x16_bf16 v[112:127], v[24:27], v[20:23], v[112:127]
    ds_read_b128 v[44:47], v161 offset:10240
    ds_read_b64_tr_b16 v[52:53], v168 offset:16384
    v_mfma_f32_32x32x16_bf16 v[80:95], v[28:31], v[16:19], v[80:95]
    ds_read_b64_tr_b16 v[54:55], v168 offset:16896
    ds_read_b64_tr_b16 v[56:57], v168 offset:18432
    v_mfma_f32_32x32x16_bf16 v[128:143], v[28:31], v[20:23], v[128:143]
    ds_read_b64_tr_b16 v[58:59], v168 offset:18944
    v_mfma_f32_32x32x16_bf16 v[96:111], v[16:19], v[32:35], v[96:111]
    v_mfma_f32_32x32x16_bf16 v[144:159], v[20:23], v[32:35], v[144:159]
    s_waitcnt lgkmcnt(0)
    v_mfma_f32_32x32x16_bf16 v[64:79], v[48:51], v[40:43], v[64:79]
    ds_read_b128 v[16:19], v162 offset:0
    ds_read_b64_tr_b16 v[24:25], v168 offset:24576
    ds_read_b64_tr_b16 v[26:27], v168 offset:25088
    v_mfma_f32_32x32x16_bf16 v[112:127], v[48:51], v[44:47], v[112:127]
    ds_read_b128 v[20:23], v162 offset:10240
    ds_read_b64_tr_b16 v[28:29], v168 offset:26624
    v_mfma_f32_32x32x16_bf16 v[80:95], v[52:55], v[40:43], v[80:95]
    ds_read_b64_tr_b16 v[30:31], v168 offset:27136
    ds_read_b64_tr_b16 v[32:33], v168 offset:28672
    v_mfma_f32_32x32x16_bf16 v[128:143], v[52:55], v[44:47], v[128:143]
    ds_read_b64_tr_b16 v[34:35], v168 offset:29184
    v_mfma_f32_32x32x16_bf16 v[96:111], v[40:43], v[56:59], v[96:111]
    v_mfma_f32_32x32x16_bf16 v[144:159], v[44:47], v[56:59], v[144:159]
    s_waitcnt lgkmcnt(0)
    v_mfma_f32_32x32x16_bf16 v[64:79], v[24:27], v[16:19], v[64:79]
    ds_read_b128 v[40:43], v163 offset:0
    ds_read_b64_tr_b16 v[48:49], v168 offset:34816
    ds_read_b64_tr_b16 v[50:51], v168 offset:35328
    v_mfma_f32_32x32x16_bf16 v[112:127], v[24:27], v[20:23], v[112:127]
    ds_read_b128 v[44:47], v163 offset:10240
    ds_read_b64_tr_b16 v[52:53], v168 offset:36864
    v_mfma_f32_32x32x16_bf16 v[80:95], v[28:31], v[16:19], v[80:95]
    ds_read_b64_tr_b16 v[54:55], v168 offset:37376
    ds_read_b64_tr_b16 v[56:57], v168 offset:38912
    v_mfma_f32_32x32x16_bf16 v[128:143], v[28:31], v[20:23], v[128:143]
    ds_read_b64_tr_b16 v[58:59], v168 offset:39424
    v_mfma_f32_32x32x16_bf16 v[96:111], v[16:19], v[32:35], v[96:111]
    v_mfma_f32_32x32x16_bf16 v[144:159], v[20:23], v[32:35], v[144:159]
    s_waitcnt lgkmcnt(0)
    v_mfma_f32_32x32x16_bf16 v[64:79], v[48:51], v[40:43], v[64:79]
    s_barrier
    ds_read_b128 v[16:19], v160 offset:40960
    ds_read_b64_tr_b16 v[24:25], v169 offset:4096
    ds_read_b64_tr_b16 v[26:27], v169 offset:4608
    v_mfma_f32_32x32x16_bf16 v[112:127], v[48:51], v[44:47], v[112:127]
    ds_read_b128 v[20:23], v160 offset:51200
    ds_read_b64_tr_b16 v[28:29], v169 offset:6144
    v_mfma_f32_32x32x16_bf16 v[80:95], v[52:55], v[40:43], v[80:95]
    ds_read_b64_tr_b16 v[30:31], v169 offset:6656
    ds_read_b64_tr_b16 v[32:33], v169 offset:8192
    v_mfma_f32_32x32x16_bf16 v[128:143], v[52:55], v[44:47], v[128:143]
    ds_read_b64_tr_b16 v[34:35], v169 offset:8704
    v_mfma_f32_32x32x16_bf16 v[96:111], v[40:43], v[56:59], v[96:111]
    v_mfma_f32_32x32x16_bf16 v[144:159], v[44:47], v[56:59], v[144:159]
    s_waitcnt lgkmcnt(0)
    v_mfma_f32_32x32x16_bf16 v[64:79], v[24:27], v[16:19], v[64:79]
    ds_read_b128 v[40:43], v161 offset:40960
    ds_read_b64_tr_b16 v[48:49], v169 offset:14336
    ds_read_b64_tr_b16 v[50:51], v169 offset:14848
    v_mfma_f32_32x32x16_bf16 v[112:127], v[24:27], v[20:23], v[112:127]
    ds_read_b128 v[44:47], v161 offset:51200
    ds_read_b64_tr_b16 v[52:53], v169 offset:16384
    v_mfma_f32_32x32x16_bf16 v[80:95], v[28:31], v[16:19], v[80:95]
    ds_read_b64_tr_b16 v[54:55], v169 offset:16896
    ds_read_b64_tr_b16 v[56:57], v169 offset:18432
    v_mfma_f32_32x32x16_bf16 v[128:143], v[28:31], v[20:23], v[128:143]
    ds_read_b64_tr_b16 v[58:59], v169 offset:18944
    v_mfma_f32_32x32x16_bf16 v[96:111], v[16:19], v[32:35], v[96:111]
    v_mfma_f32_32x32x16_bf16 v[144:159], v[20:23], v[32:35], v[144:159]
    s_waitcnt lgkmcnt(0)
    v_mfma_f32_32x32x16_bf16 v[64:79], v[48:51], v[40:43], v[64:79]
    ds_read_b128 v[16:19], v162 offset:40960
    ds_read_b64_tr_b16 v[24:25], v169 offset:24576
    ds_read_b64_tr_b16 v[26:27], v169 offset:25088
    v_mfma_f32_32x32x16_bf16 v[112:127], v[48:51], v[44:47], v[112:127]
    ds_read_b128 v[20:23], v162 offset:51200
    ds_read_b64_tr_b16 v[28:29], v169 offset:26624
    v_mfma_f32_32x32x16_bf16 v[80:95], v[52:55], v[40:43], v[80:95]
    ds_read_b64_tr_b16 v[30:31], v169 offset:27136
    ds_read_b64_tr_b16 v[32:33], v169 offset:28672
    v_mfma_f32_32x32x16_bf16 v[128:143], v[52:55], v[44:47], v[128:143]
    ds_read_b64_tr_b16 v[34:35], v169 offset:29184
    v_mfma_f32_32x32x16_bf16 v[96:111], v[40:43], v[56:59], v[96:111]
    v_mfma_f32_32x32x16_bf16 v[144:159], v[44:47], v[56:59], v[144:159]
    s_waitcnt lgkmcnt(0)
    v_mfma_f32_32x32x16_bf16 v[64:79], v[24:27], v[16:19], v[64:79]
    ds_read_b128 v[40:43], v163 offset:40960
    ds_read_b64_tr_b16 v[48:49], v169 offset:34816
    ds_read_b64_tr_b16 v[50:51], v169 offset:35328
    v_mfma_f32_32x32x16_bf16 v[112:127], v[24:27], v[20:23], v[112:127]
    ds_read_b128 v[44:47], v163 offset:51200
    ds_read_b64_tr_b16 v[52:53], v169 offset:36864
    v_mfma_f32_32x32x16_bf16 v[80:95], v[28:31], v[16:19], v[80:95]
    ds_read_b64_tr_b16 v[54:55], v169 offset:37376
    ds_read_b64_tr_b16 v[56:57], v169 offset:38912
    v_mfma_f32_32x32x16_bf16 v[128:143], v[28:31], v[20:23], v[128:143]
    ds_read_b64_tr_b16 v[58:59], v169 offset:39424
    v_mfma_f32_32x32x16_bf16 v[96:111], v[16:19], v[32:35], v[96:111]
    v_mfma_f32_32x32x16_bf16 v[144:159], v[20:23], v[32:35], v[144:159]
    s_waitcnt lgkmcnt(0)
    v_mfma_f32_32x32x16_bf16 v[64:79], v[48:51], v[40:43], v[64:79]
    s_barrier
    ds_read_b128 v[16:19], v164 offset:0
    ds_read_b64_tr_b16 v[24:25], v170 offset:4096
    ds_read_b64_tr_b16 v[26:27], v170 offset:4608
    v_mfma_f32_32x32x16_bf16 v[112:127], v[48:51], v[44:47], v[112:127]
    ds_read_b128 v[20:23], v164 offset:10240
    ds_read_b64_tr_b16 v[28:29], v170 offset:6144
    v_mfma_f32_32x32x16_bf16 v[80:95], v[52:55], v[40:43], v[80:95]
    ds_read_b64_tr_b16 v[30:31], v170 offset:6656
    ds_read_b64_tr_b16 v[32:33], v170 offset:8192
    v_mfma_f32_32x32x16_bf16 v[128:143], v[52:55], v[44:47], v[128:143]
    ds_read_b64_tr_b16 v[34:35], v170 offset:8704
    v_mfma_f32_32x32x16_bf16 v[96:111], v[40:43], v[56:59], v[96:111]
    v_mfma_f32_32x32x16_bf16 v[144:159], v[44:47], v[56:59], v[144:159]
    s_waitcnt lgkmcnt(0)
    v_mfma_f32_32x32x16_bf16 v[64:79], v[24:27], v[16:19], v[64:79]
    ds_read_b128 v[40:43], v165 offset:0
    ds_read_b64_tr_b16 v[48:49], v170 offset:14336
    ds_read_b64_tr_b16 v[50:51], v170 offset:14848
    v_mfma_f32_32x32x16_bf16 v[112:127], v[24:27], v[20:23], v[112:127]
    ds_read_b128 v[44:47], v165 offset:10240
    ds_read_b64_tr_b16 v[52:53], v170 offset:16384
    v_mfma_f32_32x32x16_bf16 v[80:95], v[28:31], v[16:19], v[80:95]
    ds_read_b64_tr_b16 v[54:55], v170 offset:16896
    ds_read_b64_tr_b16 v[56:57], v170 offset:18432
    v_mfma_f32_32x32x16_bf16 v[128:143], v[28:31], v[20:23], v[128:143]
    ds_read_b64_tr_b16 v[58:59], v170 offset:18944
    v_mfma_f32_32x32x16_bf16 v[96:111], v[16:19], v[32:35], v[96:111]
    v_mfma_f32_32x32x16_bf16 v[144:159], v[20:23], v[32:35], v[144:159]
    s_waitcnt lgkmcnt(0)
    v_mfma_f32_32x32x16_bf16 v[64:79], v[48:51], v[40:43], v[64:79]
    ds_read_b128 v[16:19], v166 offset:0
    ds_read_b64_tr_b16 v[24:25], v170 offset:24576
    ds_read_b64_tr_b16 v[26:27], v170 offset:25088
    v_mfma_f32_32x32x16_bf16 v[112:127], v[48:51], v[44:47], v[112:127]
    ds_read_b128 v[20:23], v166 offset:10240
    ds_read_b64_tr_b16 v[28:29], v170 offset:26624
    v_mfma_f32_32x32x16_bf16 v[80:95], v[52:55], v[40:43], v[80:95]
    ds_read_b64_tr_b16 v[30:31], v170 offset:27136
    ds_read_b64_tr_b16 v[32:33], v170 offset:28672
    v_mfma_f32_32x32x16_bf16 v[128:143], v[52:55], v[44:47], v[128:143]
    ds_read_b64_tr_b16 v[34:35], v170 offset:29184
    v_mfma_f32_32x32x16_bf16 v[96:111], v[40:43], v[56:59], v[96:111]
    v_mfma_f32_32x32x16_bf16 v[144:159], v[44:47], v[56:59], v[144:159]
    s_waitcnt lgkmcnt(0)
    v_mfma_f32_32x32x16_bf16 v[64:79], v[24:27], v[16:19], v[64:79]
    ds_read_b128 v[40:43], v167 offset:0
    ds_read_b64_tr_b16 v[48:49], v170 offset:34816
    ds_read_b64_tr_b16 v[50:51], v170 offset:35328
    v_mfma_f32_32x32x16_bf16 v[112:127], v[24:27], v[20:23], v[112:127]
    ds_read_b128 v[44:47], v167 offset:10240
    ds_read_b64_tr_b16 v[52:53], v170 offset:36864
    v_mfma_f32_32x32x16_bf16 v[80:95], v[28:31], v[16:19], v[80:95]
    ds_read_b64_tr_b16 v[54:55], v170 offset:37376
    ds_read_b64_tr_b16 v[56:57], v170 offset:38912
    v_mfma_f32_32x32x16_bf16 v[128:143], v[28:31], v[20:23], v[128:143]
    ds_read_b64_tr_b16 v[58:59], v170 offset:39424
    v_mfma_f32_32x32x16_bf16 v[96:111], v[16:19], v[32:35], v[96:111]
    v_mfma_f32_32x32x16_bf16 v[144:159], v[20:23], v[32:35], v[144:159]
    s_waitcnt lgkmcnt(0)
    v_mfma_f32_32x32x16_bf16 v[64:79], v[48:51], v[40:43], v[64:79]
    s_barrier
    ds_read_b128 v[16:19], v164 offset:40960
    ds_read_b64_tr_b16 v[24:25], v171 offset:4096
    ds_read_b64_tr_b16 v[26:27], v171 offset:4608
    v_mfma_f32_32x32x16_bf16 v[112:127], v[48:51], v[44:47], v[112:127]
    ds_read_b128 v[20:23], v164 offset:51200
    ds_read_b64_tr_b16 v[28:29], v171 offset:6144
    v_mfma_f32_32x32x16_bf16 v[80:95], v[52:55], v[40:43], v[80:95]
    ds_read_b64_tr_b16 v[30:31], v171 offset:6656
    ds_read_b64_tr_b16 v[32:33], v171 offset:8192
    v_mfma_f32_32x32x16_bf16 v[128:143], v[52:55], v[44:47], v[128:143]
    ds_read_b64_tr_b16 v[34:35], v171 offset:8704
    v_mfma_f32_32x32x16_bf16 v[96:111], v[40:43], v[56:59], v[96:111]
    v_mfma_f32_32x32x16_bf16 v[144:159], v[44:47], v[56:59], v[144:159]
    s_waitcnt lgkmcnt(0)
    v_mfma_f32_32x32x16_bf16 v[64:79], v[24:27], v[16:19], v[64:79]
    ds_read_b128 v[40:43], v165 offset:40960
    ds_read_b64_tr_b16 v[48:49], v171 offset:14336
    ds_read_b64_tr_b16 v[50:51], v171 offset:14848
    v_mfma_f32_32x32x16_bf16 v[112:127], v[24:27], v[20:23], v[112:127]
    ds_read_b128 v[44:47], v165 offset:51200
    ds_read_b64_tr_b16 v[52:53], v171 offset:16384
    v_mfma_f32_32x32x16_bf16 v[80:95], v[28:31], v[16:19], v[80:95]
    ds_read_b64_tr_b16 v[54:55], v171 offset:16896
    ds_read_b64_tr_b16 v[56:57], v171 offset:18432
    v_mfma_f32_32x32x16_bf16 v[128:143], v[28:31], v[20:23], v[128:143]
    ds_read_b64_tr_b16 v[58:59], v171 offset:18944
    v_mfma_f32_32x32x16_bf16 v[96:111], v[16:19], v[32:35], v[96:111]
    v_mfma_f32_32x32x16_bf16 v[144:159], v[20:23], v[32:35], v[144:159]
    s_waitcnt lgkmcnt(0)
    v_mfma_f32_32x32x16_bf16 v[64:79], v[48:51], v[40:43], v[64:79]
    ds_read_b128 v[16:19], v166 offset:40960
    ds_read_b64_tr_b16 v[24:25], v171 offset:24576
    ds_read_b64_tr_b16 v[26:27], v171 offset:25088
    v_mfma_f32_32x32x16_bf16 v[112:127], v[48:51], v[44:47], v[112:127]
    ds_read_b128 v[20:23], v166 offset:51200
    ds_read_b64_tr_b16 v[28:29], v171 offset:26624
    v_mfma_f32_32x32x16_bf16 v[80:95], v[52:55], v[40:43], v[80:95]
    ds_read_b64_tr_b16 v[30:31], v171 offset:27136
    ds_read_b64_tr_b16 v[32:33], v171 offset:28672
    v_mfma_f32_32x32x16_bf16 v[128:143], v[52:55], v[44:47], v[128:143]
    ds_read_b64_tr_b16 v[34:35], v171 offset:29184
    v_mfma_f32_32x32x16_bf16 v[96:111], v[40:43], v[56:59], v[96:111]
    v_mfma_f32_32x32x16_bf16 v[144:159], v[44:47], v[56:59], v[144:159]
    s_waitcnt lgkmcnt(0)
    v_mfma_f32_32x32x16_bf16 v[64:79], v[24:27], v[16:19], v[64:79]
    ds_read_b128 v[40:43], v167 offset:40960
    ds_read_b64_tr_b16 v[48:49], v171 offset:34816
    ds_read_b64_tr_b16 v[50:51], v171 offset:35328
    v_mfma_f32_32x32x16_bf16 v[112:127], v[24:27], v[20:23], v[112:127]
    ds_read_b128 v[44:47], v167 offset:51200
    ds_read_b64_tr_b16 v[52:53], v171 offset:36864
    v_mfma_f32_32x32x16_bf16 v[80:95], v[28:31], v[16:19], v[80:95]
    ds_read_b64_tr_b16 v[54:55], v171 offset:37376
    ds_read_b64_tr_b16 v[56:57], v171 offset:38912
    v_mfma_f32_32x32x16_bf16 v[128:143], v[28:31], v[20:23], v[128:143]
    ds_read_b64_tr_b16 v[58:59], v171 offset:39424
    v_mfma_f32_32x32x16_bf16 v[96:111], v[16:19], v[32:35], v[96:111]
    v_mfma_f32_32x32x16_bf16 v[144:159], v[20:23], v[32:35], v[144:159]
    s_waitcnt lgkmcnt(0)
    v_mfma_f32_32x32x16_bf16 v[64:79], v[48:51], v[40:43], v[64:79]
    s_barrier
    ds_read_b128 v[16:19], v160 offset:0
    ds_read_b64_tr_b16 v[24:25], v168 offset:4096
    ds_read_b64_tr_b16 v[26:27], v168 offset:4608
    v_mfma_f32_32x32x16_bf16 v[112:127], v[48:51], v[44:47], v[112:127]
    ds_read_b128 v[20:23], v160 offset:10240
    ds_read_b64_tr_b16 v[28:29], v168 offset:6144
    v_mfma_f32_32x32x16_bf16 v[80:95], v[52:55], v[40:43], v[80:95]
    ds_read_b64_tr_b16 v[30:31], v168 offset:6656
    ds_read_b64_tr_b16 v[32:33], v168 offset:8192
    v_mfma_f32_32x32x16_bf16 v[128:143], v[52:55], v[44:47], v[128:143]
    ds_read_b64_tr_b16 v[34:35], v168 offset:8704
    v_mfma_f32_32x32x16_bf16 v[96:111], v[40:43], v[56:59], v[96:111]
    s_add_u32 s6, s6, 1
    s_cmp_lt_u32 s6, 3
    v_mfma_f32_32x32x16_bf16 v[144:159], v[44:47], v[56:59], v[144:159]
    s_cbranch_scc1 P1_LOOP
    s_waitcnt lgkmcnt(0)
    v_mfma_f32_32x32x16_bf16 v[64:79], v[24:27], v[16:19], v[64:79]
    ds_read_b128 v[40:43], v161 offset:0
    ds_read_b64_tr_b16 v[48:49], v168 offset:14336
    ds_read_b64_tr_b16 v[50:51], v168 offset:14848
    v_mfma_f32_32x32x16_bf16 v[112:127], v[24:27], v[20:23], v[112:127]
    ds_read_b128 v[44:47], v161 offset:10240
    ds_read_b64_tr_b16 v[52:53], v168 offset:16384
    v_mfma_f32_32x32x16_bf16 v[80:95], v[28:31], v[16:19], v[80:95]
    ds_read_b64_tr_b16 v[54:55], v168 offset:16896
    ds_read_b64_tr_b16 v[56:57], v168 offset:18432
    v_mfma_f32_32x32x16_bf16 v[128:143], v[28:31], v[20:23], v[128:143]
    ds_read_b64_tr_b16 v[58:59], v168 offset:18944
    v_mfma_f32_32x32x16_bf16 v[96:111], v[16:19], v[32:35], v[96:111]
    v_mfma_f32_32x32x16_bf16 v[144:159], v[20:23], v[32:35], v[144:159]
    s_waitcnt lgkmcnt(0)
    v_mfma_f32_32x32x16_bf16 v[64:79], v[48:51], v[40:43], v[64:79]
    ds_read_b128 v[16:19], v162 offset:0
    ds_read_b64_tr_b16 v[24:25], v168 offset:24576
    ds_read_b64_tr_b16 v[26:27], v168 offset:25088
    v_mfma_f32_32x32x16_bf16 v[112:127], v[48:51], v[44:47], v[112:127]
    ds_read_b128 v[20:23], v162 offset:10240
    ds_read_b64_tr_b16 v[28:29], v168 offset:26624
    v_mfma_f32_32x32x16_bf16 v[80:95], v[52:55], v[40:43], v[80:95]
    ds_read_b64_tr_b16 v[30:31], v168 offset:27136
    ds_read_b64_tr_b16 v[32:33], v168 offset:28672
    v_mfma_f32_32x32x16_bf16 v[128:143], v[52:55], v[44:47], v[128:143]
    ds_read_b64_tr_b16 v[34:35], v168 offset:29184
    v_mfma_f32_32x32x16_bf16 v[96:111], v[40:43], v[56:59], v[96:111]
    v_mfma_f32_32x32x16_bf16 v[144:159], v[44:47], v[56:59], v[144:159]
    s_waitcnt lgkmcnt(0)
    v_mfma_f32_32x32x16_bf16 v[64:79], v[24:27], v[16:19], v[64:79]
    ds_read_b128 v[40:43], v163 offset:0
    ds_read_b64_tr_b16 v[48:49], v168 offset:34816
    ds_read_b64_tr_b16 v[50:51], v168 offset:35328
    v_mfma_f32_32x32x16_bf16 v[112:127], v[24:27], v[20:23], v[112:127]
    ds_read_b128 v[44:47], v163 offset:10240
    ds_read_b64_tr_b16 v[52:53], v168 offset:36864
    v_mfma_f32_32x32x16_bf16 v[80:95], v[28:31], v[16:19], v[80:95]
    ds_read_b64_tr_b16 v[54:55], v168 offset:37376
    ds_read_b64_tr_b16 v[56:57], v168 offset:38912
    v_mfma_f32_32x32x16_bf16 v[128:143], v[28:31], v[20:23], v[128:143]
    ds_read_b64_tr_b16 v[58:59], v168 offset:39424
    v_mfma_f32_32x32x16_bf16 v[96:111], v[16:19], v[32:35], v[96:111]
    v_mfma_f32_32x32x16_bf16 v[144:159], v[20:23], v[32:35], v[144:159]
    s_waitcnt lgkmcnt(0)
    v_mfma_f32_32x32x16_bf16 v[64:79], v[48:51], v[40:43], v[64:79]
    s_barrier
    ds_read_b128 v[16:19], v160 offset:40960
    ds_read_b64_tr_b16 v[24:25], v169 offset:4096
    ds_read_b64_tr_b16 v[26:27], v169 offset:4608
    v_mfma_f32_32x32x16_bf16 v[112:127], v[48:51], v[44:47], v[112:127]
    ds_read_b128 v[20:23], v160 offset:51200
    ds_read_b64_tr_b16 v[28:29], v169 offset:6144
    v_mfma_f32_32x32x16_bf16 v[80:95], v[52:55], v[40:43], v[80:95]
    ds_read_b64_tr_b16 v[30:31], v169 offset:6656
    ds_read_b64_tr_b16 v[32:33], v169 offset:8192
    v_mfma_f32_32x32x16_bf16 v[128:143], v[52:55], v[44:47], v[128:143]
    ds_read_b64_tr_b16 v[34:35], v169 offset:8704
    v_mfma_f32_32x32x16_bf16 v[96:111], v[40:43], v[56:59], v[96:111]
    v_mfma_f32_32x32x16_bf16 v[144:159], v[44:47], v[56:59], v[144:159]
    s_waitcnt lgkmcnt(0)
    v_mfma_f32_32x32x16_bf16 v[64:79], v[24:27], v[16:19], v[64:79]
    ds_read_b128 v[40:43], v161 offset:40960
    ds_read_b64_tr_b16 v[48:49], v169 offset:14336
    ds_read_b64_tr_b16 v[50:51], v169 offset:14848
    v_mfma_f32_32x32x16_bf16 v[112:127], v[24:27], v[20:23], v[112:127]
    ds_read_b128 v[44:47], v161 offset:51200
    ds_read_b64_tr_b16 v[52:53], v169 offset:16384
    v_mfma_f32_32x32x16_bf16 v[80:95], v[28:31], v[16:19], v[80:95]
    ds_read_b64_tr_b16 v[54:55], v169 offset:16896
    ds_read_b64_tr_b16 v[56:57], v169 offset:18432
    v_mfma_f32_32x32x16_bf16 v[128:143], v[28:31], v[20:23], v[128:143]
    ds_read_b64_tr_b16 v[58:59], v169 offset:18944
    v_mfma_f32_32x32x16_bf16 v[96:111], v[16:19], v[32:35], v[96:111]
    v_mfma_f32_32x32x16_bf16 v[144:159], v[20:23], v[32:35], v[144:159]
    s_waitcnt lgkmcnt(0)
    v_mfma_f32_32x32x16_bf16 v[64:79], v[48:51], v[40:43], v[64:79]
    ds_read_b128 v[16:19], v162 offset:40960
    ds_read_b64_tr_b16 v[24:25], v169 offset:24576
    ds_read_b64_tr_b16 v[26:27], v169 offset:25088
    v_mfma_f32_32x32x16_bf16 v[112:127], v[48:51], v[44:47], v[112:127]
    ds_read_b128 v[20:23], v162 offset:51200
    ds_read_b64_tr_b16 v[28:29], v169 offset:26624
    v_mfma_f32_32x32x16_bf16 v[80:95], v[52:55], v[40:43], v[80:95]
    ds_read_b64_tr_b16 v[30:31], v169 offset:27136
    ds_read_b64_tr_b16 v[32:33], v169 offset:28672
    v_mfma_f32_32x32x16_bf16 v[128:143], v[52:55], v[44:47], v[128:143]
    ds_read_b64_tr_b16 v[34:35], v169 offset:29184
    v_mfma_f32_32x32x16_bf16 v[96:111], v[40:43], v[56:59], v[96:111]
    v_mfma_f32_32x32x16_bf16 v[144:159], v[44:47], v[56:59], v[144:159]
    s_waitcnt lgkmcnt(0)
    v_mfma_f32_32x32x16_bf16 v[64:79], v[24:27], v[16:19], v[64:79]
    ds_read_b128 v[40:43], v163 offset:40960
    ds_read_b64_tr_b16 v[48:49], v169 offset:34816
    ds_read_b64_tr_b16 v[50:51], v169 offset:35328
    v_mfma_f32_32x32x16_bf16 v[112:127], v[24:27], v[20:23], v[112:127]
    ds_read_b128 v[44:47], v163 offset:51200
    ds_read_b64_tr_b16 v[52:53], v169 offset:36864
    v_mfma_f32_32x32x16_bf16 v[80:95], v[28:31], v[16:19], v[80:95]
    ds_read_b64_tr_b16 v[54:55], v169 offset:37376
    ds_read_b64_tr_b16 v[56:57], v169 offset:38912
    v_mfma_f32_32x32x16_bf16 v[128:143], v[28:31], v[20:23], v[128:143]
    ds_read_b64_tr_b16 v[58:59], v169 offset:39424
    v_mfma_f32_32x32x16_bf16 v[96:111], v[16:19], v[32:35], v[96:111]
    v_mfma_f32_32x32x16_bf16 v[144:159], v[20:23], v[32:35], v[144:159]
    s_waitcnt lgkmcnt(0)
    v_mfma_f32_32x32x16_bf16 v[64:79], v[48:51], v[40:43], v[64:79]
    s_barrier
    ds_read_b128 v[16:19], v164 offset:0
    ds_read_b64_tr_b16 v[24:25], v170 offset:4096
    ds_read_b64_tr_b16 v[26:27], v170 offset:4608
    v_mfma_f32_32x32x16_bf16 v[112:127], v[48:51], v[44:47], v[112:127]
    ds_read_b128 v[20:23], v164 offset:10240
    ds_read_b64_tr_b16 v[28:29], v170 offset:6144
    v_mfma_f32_32x32x16_bf16 v[80:95], v[52:55], v[40:43], v[80:95]
    ds_read_b64_tr_b16 v[30:31], v170 offset:6656
    ds_read_b64_tr_b16 v[32:33], v170 offset:8192
    v_mfma_f32_32x32x16_bf16 v[128:143], v[52:55], v[44:47], v[128:143]
    ds_read_b64_tr_b16 v[34:35], v170 offset:8704
    v_mfma_f32_32x32x16_bf16 v[96:111], v[40:43], v[56:59], v[96:111]
    v_mfma_f32_32x32x16_bf16 v[144:159], v[44:47], v[56:59], v[144:159]
    s_waitcnt lgkmcnt(0)
    v_mfma_f32_32x32x16_bf16 v[64:79], v[24:27], v[16:19], v[64:79]
    ds_read_b128 v[40:43], v165 offset:0
    ds_read_b64_tr_b16 v[48:49], v170 offset:14336
    ds_read_b64_tr_b16 v[50:51], v170 offset:14848
    v_mfma_f32_32x32x16_bf16 v[112:127], v[24:27], v[20:23], v[112:127]
    ds_read_b128 v[44:47], v165 offset:10240
    ds_read_b64_tr_b16 v[52:53], v170 offset:16384
    v_mfma_f32_32x32x16_bf16 v[80:95], v[28:31], v[16:19], v[80:95]
    ds_read_b64_tr_b16 v[54:55], v170 offset:16896
    ds_read_b64_tr_b16 v[56:57], v170 offset:18432
    v_mfma_f32_32x32x16_bf16 v[128:143], v[28:31], v[20:23], v[128:143]
    ds_read_b64_tr_b16 v[58:59], v170 offset:18944
    v_mfma_f32_32x32x16_bf16 v[96:111], v[16:19], v[32:35], v[96:111]
    v_mfma_f32_32x32x16_bf16 v[144:159], v[20:23], v[32:35], v[144:159]
    s_waitcnt lgkmcnt(0)
    v_mfma_f32_32x32x16_bf16 v[64:79], v[48:51], v[40:43], v[64:79]
    ds_read_b128 v[16:19], v166 offset:0
    ds_read_b64_tr_b16 v[24:25], v170 offset:24576
    ds_read_b64_tr_b16 v[26:27], v170 offset:25088
    v_mfma_f32_32x32x16_bf16 v[112:127], v[48:51], v[44:47], v[112:127]
    ds_read_b128 v[20:23], v166 offset:10240
    ds_read_b64_tr_b16 v[28:29], v170 offset:26624
    v_mfma_f32_32x32x16_bf16 v[80:95], v[52:55], v[40:43], v[80:95]
    ds_read_b64_tr_b16 v[30:31], v170 offset:27136
    ds_read_b64_tr_b16 v[32:33], v170 offset:28672
    v_mfma_f32_32x32x16_bf16 v[128:143], v[52:55], v[44:47], v[128:143]
    ds_read_b64_tr_b16 v[34:35], v170 offset:29184
    v_mfma_f32_32x32x16_bf16 v[96:111], v[40:43], v[56:59], v[96:111]
    v_mfma_f32_32x32x16_bf16 v[144:159], v[44:47], v[56:59], v[144:159]
    s_waitcnt lgkmcnt(0)
    v_mfma_f32_32x32x16_bf16 v[64:79], v[24:27], v[16:19], v[64:79]
    ds_read_b128 v[40:43], v167 offset:0
    ds_read_b64_tr_b16 v[48:49], v170 offset:34816
    ds_read_b64_tr_b16 v[50:51], v170 offset:35328
    v_mfma_f32_32x32x16_bf16 v[112:127], v[24:27], v[20:23], v[112:127]
    ds_read_b128 v[44:47], v167 offset:10240
    ds_read_b64_tr_b16 v[52:53], v170 offset:36864
    v_mfma_f32_32x32x16_bf16 v[80:95], v[28:31], v[16:19], v[80:95]
    ds_read_b64_tr_b16 v[54:55], v170 offset:37376
    ds_read_b64_tr_b16 v[56:57], v170 offset:38912
    v_mfma_f32_32x32x16_bf16 v[128:143], v[28:31], v[20:23], v[128:143]
    ds_read_b64_tr_b16 v[58:59], v170 offset:39424
    v_mfma_f32_32x32x16_bf16 v[96:111], v[16:19], v[32:35], v[96:111]
    v_mfma_f32_32x32x16_bf16 v[144:159], v[20:23], v[32:35], v[144:159]
    s_waitcnt lgkmcnt(0)
    v_mfma_f32_32x32x16_bf16 v[64:79], v[48:51], v[40:43], v[64:79]
    s_barrier
    ds_read_b128 v[16:19], v164 offset:40960
    ds_read_b64_tr_b16 v[24:25], v171 offset:4096
    ds_read_b64_tr_b16 v[26:27], v171 offset:4608
    ds_read_b128 v[20:23], v164 offset:51200
    v_mfma_f32_32x32x16_bf16 v[112:127], v[48:51], v[44:47], v[112:127]
    ds_read_b64_tr_b16 v[28:29], v171 offset:6144
    ds_read_b64_tr_b16 v[30:31], v171 offset:6656
    ds_read_b64_tr_b16 v[32:33], v171 offset:8192
    ds_read_b64_tr_b16 v[34:35], v171 offset:8704
    v_mfma_f32_32x32x16_bf16 v[80:95], v[52:55], v[40:43], v[80:95]
    ds_read_b128 v[176:179], v165 offset:40960
    ds_read_b64_tr_b16 v[184:185], v171 offset:14336
    ds_read_b64_tr_b16 v[186:187], v171 offset:14848
    ds_read_b128 v[180:183], v165 offset:51200
    v_mfma_f32_32x32x16_bf16 v[128:143], v[52:55], v[44:47], v[128:143]
    ds_read_b64_tr_b16 v[188:189], v171 offset:16384
    ds_read_b64_tr_b16 v[190:191], v171 offset:16896
    ds_read_b64_tr_b16 v[192:193], v171 offset:18432
    ds_read_b64_tr_b16 v[194:195], v171 offset:18944
    v_mfma_f32_32x32x16_bf16 v[96:111], v[40:43], v[56:59], v[96:111]
    ds_read_b128 v[200:203], v166 offset:40960
    ds_read_b64_tr_b16 v[208:209], v171 offset:24576
    ds_read_b64_tr_b16 v[210:211], v171 offset:25088
    ds_read_b128 v[204:207], v166 offset:51200
    v_mfma_f32_32x32x16_bf16 v[144:159], v[44:47], v[56:59], v[144:159]
    ds_read_b64_tr_b16 v[212:213], v171 offset:26624
    ds_read_b64_tr_b16 v[214:215], v171 offset:27136
    ds_read_b64_tr_b16 v[216:217], v171 offset:28672
    ds_read_b64_tr_b16 v[218:219], v171 offset:29184
    ds_read_b128 v[40:43], v167 offset:40960
    ds_read_b64_tr_b16 v[48:49], v171 offset:34816
    ds_read_b64_tr_b16 v[50:51], v171 offset:35328
    ds_read_b128 v[44:47], v167 offset:51200
    ds_read_b64_tr_b16 v[52:53], v171 offset:36864
    ds_read_b64_tr_b16 v[54:55], v171 offset:37376
    ds_read_b64_tr_b16 v[56:57], v171 offset:38912
    ds_read_b64_tr_b16 v[58:59], v171 offset:39424
    s_waitcnt lgkmcnt(8)
    v_mfma_f32_32x32x16_bf16 v[64:79], v[24:27], v[16:19], v[64:79]
    v_mfma_f32_32x32x16_bf16 v[64:79], v[184:187], v[176:179], v[64:79]
    v_mfma_f32_32x32x16_bf16 v[64:79], v[208:211], v[200:203], v[64:79]
    s_waitcnt lgkmcnt(0)
    v_mfma_f32_32x32x16_bf16 v[64:79], v[48:51], v[40:43], v[64:79]
    s_barrier
    v_mfma_f32_32x32x16_bf16 v[112:127], v[24:27], v[20:23], v[112:127]
    v_mfma_f32_32x32x16_bf16 v[112:127], v[184:187], v[180:183], v[112:127]
    s_nop 3
    v_mfma_f32_32x32x16_bf16 v[112:127], v[208:211], v[204:207], v[112:127]
    s_nop 3
    v_mfma_f32_32x32x16_bf16 v[112:127], v[48:51], v[44:47], v[112:127]
    v_mfma_f32_32x32x16_bf16 v[80:95], v[28:31], v[16:19], v[80:95]
    v_mul_f32 v64, s12, v64
    v_mul_f32 v65, s12, v65
    v_mul_f32 v66, s12, v66
    v_mul_f32 v67, s12, v67
    v_mul_f32 v68, s12, v68
    v_mul_f32 v69, s12, v69
    v_mul_f32 v70, s12, v70
    v_mfma_f32_32x32x16_bf16 v[80:95], v[188:191], v[176:179], v[80:95]
    v_mul_f32 v71, s12, v71
    v_mul_f32 v72, s12, v72
    v_mul_f32 v73, s12, v73
    v_mul_f32 v74, s12, v74
    v_mul_f32 v75, s12, v75
    v_mul_f32 v76, s12, v76
    v_mul_f32 v77, s12, v77
    v_mfma_f32_32x32x16_bf16 v[80:95], v[212:215], v[200:203], v[80:95]
    v_mul_f32 v78, s12, v78
    v_mul_f32 v79, s12, v79
    v_cvt_pk_bf16_f32 v64, v64, v65
    v_cvt_pk_bf16_f32 v65, v66, v67
    v_cvt_pk_bf16_f32 v66, v68, v69
    v_cvt_pk_bf16_f32 v67, v70, v71
    v_cvt_pk_bf16_f32 v68, v72, v73
    v_mfma_f32_32x32x16_bf16 v[80:95], v[52:55], v[40:43], v[80:95]
    v_cvt_pk_bf16_f32 v69, v74, v75
    v_cvt_pk_bf16_f32 v70, v76, v77
    v_cvt_pk_bf16_f32 v71, v78, v79
    buffer_store_dwordx4 v[64:67], v1, s[8:11], s13 offen offset:0 sc1
    buffer_store_dwordx4 v[68:71], v1, s[8:11], s13 offen offset:1024 sc1
    ds_write_b128 v10, v[64:67] offset:0
    ds_write_b128 v10, v[68:71] offset:1024
    v_mfma_f32_32x32x16_bf16 v[128:143], v[28:31], v[20:23], v[128:143]
    v_mul_f32 v112, s12, v112
    v_mul_f32 v113, s12, v113
    v_mul_f32 v114, s12, v114
    v_mul_f32 v115, s12, v115
    v_mul_f32 v116, s12, v116
    v_mul_f32 v117, s12, v117
    v_mul_f32 v118, s12, v118
    v_mfma_f32_32x32x16_bf16 v[128:143], v[188:191], v[180:183], v[128:143]
    v_mul_f32 v119, s12, v119
    v_mul_f32 v120, s12, v120
    v_mul_f32 v121, s12, v121
    v_mul_f32 v122, s12, v122
    v_mul_f32 v123, s12, v123
    v_mul_f32 v124, s12, v124
    v_mul_f32 v125, s12, v125
    v_mfma_f32_32x32x16_bf16 v[128:143], v[212:215], v[204:207], v[128:143]
    v_mul_f32 v126, s12, v126
    v_mul_f32 v127, s12, v127
    v_cvt_pk_bf16_f32 v112, v112, v113
    v_cvt_pk_bf16_f32 v113, v114, v115
    v_cvt_pk_bf16_f32 v114, v116, v117
    v_cvt_pk_bf16_f32 v115, v118, v119
    v_cvt_pk_bf16_f32 v116, v120, v121
    v_mfma_f32_32x32x16_bf16 v[128:143], v[52:55], v[44:47], v[128:143]
    v_cvt_pk_bf16_f32 v117, v122, v123
    v_cvt_pk_bf16_f32 v118, v124, v125
    v_cvt_pk_bf16_f32 v119, v126, v127
    buffer_store_dwordx4 v[112:115], v1, s[8:11], s13 offen offset:2048 sc1
    buffer_store_dwordx4 v[116:119], v1, s[8:11], s13 offen offset:3072 sc1
    ds_write_b128 v10, v[112:115] offset:2048
    ds_write_b128 v10, v[116:119] offset:3072
    v_mfma_f32_32x32x16_bf16 v[96:111], v[16:19], v[32:35], v[96:111]
    v_cvt_pk_bf16_f32 v80, v80, v81
    v_cvt_pk_bf16_f32 v81, v82, v83
    v_cvt_pk_bf16_f32 v82, v84, v85
    v_mfma_f32_32x32x16_bf16 v[96:111], v[176:179], v[192:195], v[96:111]
    v_cvt_pk_bf16_f32 v83, v86, v87
    v_cvt_pk_bf16_f32 v84, v88, v89
    v_cvt_pk_bf16_f32 v85, v90, v91
    v_mfma_f32_32x32x16_bf16 v[96:111], v[200:203], v[216:219], v[96:111]
    v_cvt_pk_bf16_f32 v86, v92, v93
    v_cvt_pk_bf16_f32 v87, v94, v95
    v_mfma_f32_32x32x16_bf16 v[96:111], v[40:43], v[56:59], v[96:111]
    buffer_store_dwordx4 v[80:83], v1, s[8:11], s14 offen offset:0 sc1
    buffer_store_dwordx4 v[84:87], v1, s[8:11], s14 offen offset:1024 sc1
    v_mfma_f32_32x32x16_bf16 v[144:159], v[20:23], v[32:35], v[144:159]
    v_cvt_pk_bf16_f32 v128, v128, v129
    v_cvt_pk_bf16_f32 v129, v130, v131
    v_cvt_pk_bf16_f32 v130, v132, v133
    v_mfma_f32_32x32x16_bf16 v[144:159], v[180:183], v[192:195], v[144:159]
    v_cvt_pk_bf16_f32 v131, v134, v135
    v_cvt_pk_bf16_f32 v132, v136, v137
    v_cvt_pk_bf16_f32 v133, v138, v139
    v_mfma_f32_32x32x16_bf16 v[144:159], v[204:207], v[216:219], v[144:159]
    v_cvt_pk_bf16_f32 v134, v140, v141
    v_cvt_pk_bf16_f32 v135, v142, v143
    v_mfma_f32_32x32x16_bf16 v[144:159], v[44:47], v[56:59], v[144:159]
    buffer_store_dwordx4 v[128:131], v1, s[8:11], s15 offen offset:0 sc1
    buffer_store_dwordx4 v[132:135], v1, s[8:11], s15 offen offset:1024 sc1
    v_mov_b32 v216, 0x7fff0000
    v_cvt_pk_bf16_f32 v96, v96, v97
    v_cvt_pk_bf16_f32 v97, v98, v99
    v_cvt_pk_bf16_f32 v98, v100, v101
    v_cvt_pk_bf16_f32 v99, v102, v103
    v_cvt_pk_bf16_f32 v100, v104, v105
    v_cvt_pk_bf16_f32 v101, v106, v107
    v_cvt_pk_bf16_f32 v102, v108, v109
    v_cvt_pk_bf16_f32 v103, v110, v111
    buffer_store_dwordx4 v[96:99], v1, s[8:11], s14 offen offset:2048 sc1
    buffer_store_dwordx4 v[100:103], v1, s[8:11], s14 offen offset:3072 sc1
    s_nop 0
    v_cvt_pk_bf16_f32 v144, v144, v145
    v_cvt_pk_bf16_f32 v145, v146, v147
    v_cvt_pk_bf16_f32 v146, v148, v149
    v_cvt_pk_bf16_f32 v147, v150, v151
    v_cvt_pk_bf16_f32 v148, v152, v153
    v_cvt_pk_bf16_f32 v149, v154, v155
    v_cvt_pk_bf16_f32 v150, v156, v157
    v_cvt_pk_bf16_f32 v151, v158, v159
    buffer_store_dwordx4 v[144:147], v1, s[8:11], s15 offen offset:2048 sc1
    buffer_store_dwordx4 v[148:151], v1, s[8:11], s15 offen offset:3072 sc1
    s_and_b32 s4, s2, 6
    s_lshl_b32 s4, s4, 2
    s_lshr_b32 s5, s2, 6
    s_lshl_b32 s5, s5, 1
    s_or_b32 s4, s4, s5
    s_bfe_u32 s5, s2, 0x10003
    s_or_b32 s4, s4, s5
    s_lshr_b32 s5, s2, 1
    s_xor_b32 s5, s5, s2
    s_and_b32 s5, s5, 1
    s_lshl_b32 s5, s5, 2
    s_bfe_u32 s6, s2, 0x20004
    s_or_b32 s5, s5, s6
    s_lshr_b32 s42, s4, 1
    s_lshl_b32 s42, s42, 11
    s_add_u32 s42, s42, 25165824
    s_lshl_b32 s12, s4, 18
    s_lshl_b32 s13, s3, 12
    s_add_u32 s12, s12, s13
    s_add_u32 s12, s12, 4194304
    s_andn2_b32 s15, 1, s4
    s_lshl_b32 s15, s15, 2
    s_add_u32 s15, s15, s3
    s_lshl_b32 s15, s15, 11
    s_lshl_b32 s14, s4, 17
    s_lshl_b32 s6, s5, 14
    s_add_u32 s14, s14, s6
    s_add_u32 s14, s14, s15
    s_waitcnt vmcnt(0)
    v_mov_b32 v3, 85248
    v_mov_b32 v4, 1
    s_mov_b64 exec, 1
    ds_add_rtn_u32 v5, v3, v4
    s_waitcnt lgkmcnt(0)
    v_readfirstlane_b32 s6, v5
    s_mov_b64 exec, -1
    s_cmp_lg_u32 s6, 3
    s_cbranch_scc1 NOPOLL1
    s_mov_b64 exec, 1
    v_mov_b32 v4, 1
    buffer_store_dword v4, v2, s[8:11], s7 offen sc1
    s_mov_b64 exec, -1
    s_lshl_b32 s43, s5, 1
    s_lshl_b32 s43, 3, s43
    s_or_b32 s43, s43, 3
    s_mov_b32 s98, 0
POLL1:
    buffer_load_dword v5, v254, s[8:11], s42 offen sc1
    s_waitcnt vmcnt(0)
    v_cmp_eq_u32 s[100:101], 1, v5
    s_and_b32 s100, s100, s43
    s_cmp_eq_u32 s100, s43
    s_cbranch_scc1 POLL1_OK
    s_sleep 2
    s_add_u32 s98, s98, 1
    s_cmp_lt_u32 s98, 0x80000
    s_cbranch_scc1 POLL1
POLL1_OK:
    v_mov_b32 v4, 64
    ds_write_b32 v3, v4
    s_branch GO1
NOPOLL1:
    s_mov_b32 s98, 0
LW1:
    s_sleep 1
    ds_read_b32 v5, v3
    s_add_u32 s98, s98, 1
    s_cmp_ge_u32 s98, 0x800000
    s_cbranch_scc1 GO1
    s_waitcnt lgkmcnt(0)
    v_readfirstlane_b32 s6, v5
    s_cmp_lg_u32 s6, 64
    s_cbranch_scc1 LW1
GO1:
    s_waitcnt lgkmcnt(0)
    s_add_u32 m0, s13, 98304
    s_nop 0
    buffer_load_dwordx4 v1, s[8:11], s12 offen offset:0 sc1 lds
    buffer_load_dwordx4 v1, s[8:11], s12 offen offset:1024 sc1 lds
    buffer_load_dwordx4 v1, s[8:11], s12 offen offset:2048 sc1 lds
    buffer_load_dwordx4 v1, s[8:11], s12 offen offset:3072 sc1 lds
    s_add_u32 m0, s15, 147456
    s_add_u32 s12, s12, 16384
    buffer_load_dwordx4 v1, s[8:11], s14 offen offset:0 sc1 lds
    buffer_load_dwordx4 v1, s[8:11], s14 offen offset:1024 sc1 lds
    s_add_u32 m0, s13, 114688
    s_nop 0
    buffer_load_dwordx4 v1, s[8:11], s12 offen offset:0 sc1 lds
    buffer_load_dwordx4 v1, s[8:11], s12 offen offset:1024 sc1 lds
    buffer_load_dwordx4 v1, s[8:11], s12 offen offset:2048 sc1 lds
    buffer_load_dwordx4 v1, s[8:11], s12 offen offset:3072 sc1 lds
    s_and_b32 s4, s2, 6
    s_lshl_b32 s4, s4, 2
    s_lshr_b32 s5, s2, 6
    s_lshl_b32 s5, s5, 1
    s_or_b32 s4, s4, s5
    s_bfe_u32 s5, s2, 0x10003
    s_or_b32 s4, s4, s5
    s_lshr_b32 s5, s2, 1
    s_xor_b32 s5, s5, s2
    s_and_b32 s5, s5, 1
    s_lshl_b32 s5, s5, 2
    s_bfe_u32 s6, s2, 0x20004
    s_or_b32 s5, s5, s6
    s_lshl_b32 s6, s4, 18
    s_add_u32 s6, s6, 4194304
    s_lshl_b32 s13, s3, 11
    s_add_u32 s12, s6, s13
    s_add_u32 s12, s12, 32768
    s_add_u32 s13, s13, 98304
    s_lshl_b32 s14, s5, 3
    s_add_u32 s14, s14, s3
    s_lshl_b32 s15, s14, 5
    s_add_u32 s15, s15, s4
    s_lshl_b32 s58, s5, 5
    s_add_u32 s58, s58, s4
    s_lshl_b32 s58, s58, 7
    s_add_u32 s58, s58, 25264128
    s_lshl_b32 s57, s2, 7
    s_add_u32 s57, s57, 25231360
    s_cmp_eq_u32 s3, 4
    s_cselect_b32 s57, s57, 0x7fff0000
    s_cselect_b32 s58, s58, 0x7fff0000
    s_lshl_b32 s15, s15, 11
    s_add_u32 s15, s15, 12582912
    v_add_u32 v128, 98304, v1
    v_add_u32 v3, s13, v1
    s_and_b32 s40, s2, 7
    s_lshl_b32 s40, s40, 1
    s_bfe_u32 s41, s2, 0x10003
    s_or_b32 s40, s40, s41
    s_lshr_b32 s41, s2, 4
    s_mov_b32 s44, s32
    s_and_b32 s45, s33, 0xffff
    s_mov_b32 s46, 2097152
    s_mov_b32 s47, 0x00020000
    s_mov_b32 s52, s16
    s_and_b32 s53, s17, 0xffff
    s_mov_b32 s54, 4194304
    s_mov_b32 s55, 0x00020000
    v_lshrrev_b32 v5, 3, v0
    v_and_b32 v6, 7, v0
    v_bfe_u32 v7, v0, 4, 1
    v_lshlrev_b32 v7, 2, v7
    v_xor_b32 v7, v7, v6
    v_lshlrev_b32 v7, 4, v7
    v_lshl_add_u32 v129, v5, 11, v7
    s_lshl_b32 s48, s3, 14
    s_lshl_b32 s49, s41, 7
    s_add_u32 s48, s48, s49
    s_lshl_b32 s49, s3, 10
    s_mov_b32 s43, s49
    s_and_b32 s59, s3, 3
    s_lshl_b32 s50, s40, 2
    s_add_u32 s59, s59, s50
    s_lshl_b32 s59, s59, 1
    s_lshr_b32 s50, s3, 2
    s_add_u32 s59, s59, s50
    s_lshl_b32 s60, s59, 15
    s_add_u32 s60, s60, 12582912
    s_lshr_b32 s59, s40, 1
    s_lshl_b32 s59, s59, 1
    s_add_u32 s59, s59, s50
    s_lshl_b32 s59, s59, 11
    s_add_u32 s59, s59, 25264128
    s_lshr_b32 s50, s2, 4
    s_lshl_b32 s50, s50, 7
    s_lshl_b32 s51, s3, 4
    s_add_u32 s50, s50, s51
    s_and_b32 s51, s2, 15
    s_lshl_b32 s56, s51, 11
    s_add_u32 s56, s56, 25231360
    s_lshl_b32 s51, s51, 6
    v_lshl_add_u32 v5, v5, 1, s50
    v_lshl_add_u32 v6, v6, 3, s51
    v_lshlrev_b32 v132, 1, v5
    v_lshl_add_u32 v132, v6, 12, v132
    v_lshlrev_b32 v133, 1, v6
    v_lshl_add_u32 v134, v5, 11, v133
    v_lshl_add_u32 v133, v5, 12, v133
    s_lshr_b32 s61, s40, 3
    s_lshl_b32 s61, s61, 1
    s_lshl_b32 s61, s61, 2
    v_xor_b32 v131, s61, v0
    v_and_b32 v131, 15, v131
    v_lshlrev_b32 v131, 7, v131
    v_add_u32 v130, s43, v128
    s_and_b32 s63, s61, 8
    s_lshl_b32 s63, 0x11, s63
    s_and_b32 s30, s41, 2
    s_lshl_b32 s30, s30, 11
    s_cmp_lt_u32 s3, 4
    s_cselect_b32 s63, 0x1111, s63
    s_mov_b32 s27, 0x7fff0000
    s_mov_b32 s28, 0x7fff0000
    v_bfe_u32 v5, v0, 2, 1
    v_cmp_eq_u32 vcc, 0, v5
    v_mov_b32 v6, 0x3f803f80
    v_and_b32 v5, 1, v0
    v_cndmask_b32 v124, 0, v6, vcc
    v_xor_b32 v126, v6, v124
    v_mov_b32 v125, v124
    v_mov_b32 v127, v126
    v_mul_u32_u24 v15, 0xaaaa, v5
    v_add_u32 v15, 0x4444, v15
    v_mov_b32 v88, 0
    v_mov_b32 v89, 0
    v_mov_b32 v90, 0
    v_mov_b32 v91, 0
P2_JOIN:
    s_cmp_lt_u32 s3, 4
    s_cselect_b64 vcc, -1, 0
    s_waitcnt vmcnt(4)
    s_barrier
    ds_read_b128 v[4:7], v3 offset:49152
    ds_read_b128 v[8:11], v3 offset:50176
    ds_read_b128 v[92:95], v128 offset:0
    ds_read_b128 v[96:99], v128 offset:1024
    ds_read_b128 v[100:103], v128 offset:4096
    ds_read_b128 v[104:107], v128 offset:5120
    ds_read_b128 v[108:111], v128 offset:2048
    ds_read_b128 v[112:115], v128 offset:3072
    s_mov_b32 s14, 0
    s_lshr_b32 s42, s4, 1
    s_lshl_b32 s42, s42, 11
    s_add_u32 s42, s42, 25165824
    buffer_load_dword v135, v254, s[8:11], s42 offen sc1
    s_waitcnt lgkmcnt(4)
    v_mfma_f32_32x32x16_bf16 v[48:63], v[92:95], v[4:7], 0
    v_mfma_f32_32x32x16_bf16 v[48:63], v[96:99], v[8:11], v[48:63]
    s_nop 7
    s_nop 3
    v_max3_f32 v12, v48, v49, v50
    v_max3_f32 v12, v12, v51, v52
    v_max3_f32 v12, v12, v53, v54
    v_max3_f32 v12, v12, v55, v56
    v_max3_f32 v12, v12, v57, v58
    v_max3_f32 v12, v12, v59, v60
    v_max3_f32 v12, v12, v61, v62
    v_max_f32 v12, v12, v63
    v_mov_b32 v13, v12
    s_nop 1
    v_permlane32_swap_b32 v12, v13
    v_max_f32 v12, v12, v13
    v_sub_f32 v32, v48, v12
    v_sub_f32 v33, v49, v12
    v_sub_f32 v34, v50, v12
    v_sub_f32 v35, v51, v12
    v_sub_f32 v36, v52, v12
    v_sub_f32 v37, v53, v12
    v_sub_f32 v38, v54, v12
    v_sub_f32 v39, v55, v12
    v_sub_f32 v40, v56, v12
    v_sub_f32 v41, v57, v12
    v_sub_f32 v42, v58, v12
    v_sub_f32 v43, v59, v12
    v_sub_f32 v44, v60, v12
    v_sub_f32 v45, v61, v12
    v_sub_f32 v46, v62, v12
    v_sub_f32 v47, v63, v12
    v_xor_b32 v16, 0x80000000, v12
    v_xor_b32 v17, 0x80000000, v12
    v_xor_b32 v18, 0x80000000, v12
    v_xor_b32 v19, 0x80000000, v12
    v_xor_b32 v20, 0x80000000, v12
    v_xor_b32 v21, 0x80000000, v12
    v_xor_b32 v22, 0x80000000, v12
    v_xor_b32 v23, 0x80000000, v12
    v_xor_b32 v24, 0x80000000, v12
    v_xor_b32 v25, 0x80000000, v12
    v_xor_b32 v26, 0x80000000, v12
    v_xor_b32 v27, 0x80000000, v12
    v_xor_b32 v28, 0x80000000, v12
    v_xor_b32 v29, 0x80000000, v12
    v_xor_b32 v30, 0x80000000, v12
    v_xor_b32 v31, 0x80000000, v12
    s_setprio 0
    s_waitcnt lgkmcnt(0)
    v_mfma_f32_32x32x16_bf16 v[48:63], v[100:103], v[4:7], v[16:31]
    ds_read_b128 v[92:95], v128 offset:8192
    ds_read_b128 v[96:99], v128 offset:9216
    v_mfma_f32_32x32x16_bf16 v[48:63], v[104:107], v[8:11], v[48:63]
    ds_read_b128 v[116:119], v128 offset:6144
    ds_read_b128 v[120:123], v128 offset:7168
    v_exp_f32 v32, v32
    v_exp_f32 v33, v33
    v_exp_f32 v34, v34
    v_exp_f32 v35, v35
    v_cvt_pk_bf16_f32 v64, v32, v33
    s_setprio 2
    v_exp_f32 v36, v36
    v_exp_f32 v37, v37
    v_cvt_pk_bf16_f32 v65, v34, v35
    v_exp_f32 v38, v38
    v_exp_f32 v39, v39
    v_cvt_pk_bf16_f32 v66, v36, v37
    v_exp_f32 v40, v40
    v_exp_f32 v41, v41
    v_cvt_pk_bf16_f32 v67, v38, v39
    v_exp_f32 v42, v42
    v_exp_f32 v43, v43
    v_cvt_pk_bf16_f32 v68, v40, v41
    v_exp_f32 v44, v44
    v_exp_f32 v45, v45
    v_cvt_pk_bf16_f32 v69, v42, v43
    v_exp_f32 v46, v46
    v_exp_f32 v47, v47
    v_cvt_pk_bf16_f32 v70, v44, v45
    v_cvt_pk_bf16_f32 v71, v46, v47
    s_setprio 0
    s_waitcnt lgkmcnt(0)
    v_mfma_f32_32x32x16_bf16 v[32:47], v[92:95], v[4:7], v[16:31]
    s_waitcnt vmcnt(0)
    v_cmp_eq_u32 s[100:101], 1, v135
    s_cmp_eq_u64 s[100:101], -1
    s_cbranch_scc1 POLL1B_OK
    s_mov_b32 s98, 0
POLL1B:
    buffer_load_dword v135, v254, s[8:11], s42 offen sc1
    s_waitcnt vmcnt(0)
    v_cmp_eq_u32 s[100:101], 1, v135
    s_cmp_eq_u64 s[100:101], -1
    s_cbranch_scc1 POLL1B_OK
    s_sleep 2
    s_add_u32 s98, s98, 1
    s_cmp_lt_u32 s98, 0x80000
    s_cbranch_scc1 POLL1B
POLL1B_OK:
    s_add_u32 m0, s13, 32768
    s_nop 0
    buffer_load_dwordx4 v1, s[8:11], s12 offen sc1 lds
    buffer_load_dwordx4 v1, s[8:11], s12 offen offset:1024 sc1 lds
    s_add_u32 s12, s12, 16384
    v_mfma_f32_32x32x16_bf16 v[72:87], v[108:111], v[64:67], 0
    v_mfma_f32_32x32x16_bf16 v[72:87], v[112:115], v[68:71], v[72:87]
    ds_read_b128 v[100:103], v128 offset:12288
    ds_read_b128 v[104:107], v128 offset:13312
    v_mfma_f32_32x32x16_bf16 v[32:47], v[96:99], v[8:11], v[32:47]
    ds_read_b128 v[108:111], v128 offset:10240
    ds_read_b128 v[112:115], v128 offset:11264
    v_smfmac_f32_16x16x64_bf16 v[88:91], v[124:127], v[64:71], v15
    s_cbranch_vccnz SKB_first_1
    s_nop 0
    s_barrier
SKB_first_1:
    v_exp_f32 v48, v48
    v_exp_f32 v49, v49
    v_exp_f32 v50, v50
    v_exp_f32 v51, v51
    v_cvt_pk_bf16_f32 v64, v48, v49
    s_setprio 2
    v_exp_f32 v52, v52
    v_exp_f32 v53, v53
    v_cvt_pk_bf16_f32 v65, v50, v51
    v_exp_f32 v54, v54
    v_exp_f32 v55, v55
    v_cvt_pk_bf16_f32 v66, v52, v53
    v_exp_f32 v56, v56
    v_exp_f32 v57, v57
    v_cvt_pk_bf16_f32 v67, v54, v55
    v_exp_f32 v58, v58
    v_exp_f32 v59, v59
    v_cvt_pk_bf16_f32 v68, v56, v57
    v_exp_f32 v60, v60
    v_exp_f32 v61, v61
    v_cvt_pk_bf16_f32 v69, v58, v59
    v_exp_f32 v62, v62
    v_exp_f32 v63, v63
    v_cvt_pk_bf16_f32 v70, v60, v61
    v_cvt_pk_bf16_f32 v71, v62, v63
    s_cbranch_vccz SKA_first_1
    s_nop 0
    s_barrier
SKA_first_1:
    s_setprio 0
    s_waitcnt lgkmcnt(0)
    v_mfma_f32_32x32x16_bf16 v[48:63], v[100:103], v[4:7], v[16:31]
    s_add_u32 m0, s13, 49152
    s_nop 0
    buffer_load_dwordx4 v1, s[8:11], s12 offen sc1 lds
    v_mfma_f32_32x32x16_bf16 v[72:87], v[116:119], v[64:67], v[72:87]
    v_mfma_f32_32x32x16_bf16 v[72:87], v[120:123], v[68:71], v[72:87]
    ds_read_b128 v[92:95], v128 offset:16384
    ds_read_b128 v[96:99], v128 offset:17408
    v_mfma_f32_32x32x16_bf16 v[48:63], v[104:107], v[8:11], v[48:63]
    ds_read_b128 v[116:119], v128 offset:14336
    ds_read_b128 v[120:123], v128 offset:15360
    v_smfmac_f32_16x16x64_bf16 v[88:91], v[124:127], v[64:71], v15
    buffer_store_dwordx2 v[200:201], v216, s[8:11], 0 offen offset:0 sc1
    v_exp_f32 v32, v32
    v_exp_f32 v33, v33
    v_exp_f32 v34, v34
    v_exp_f32 v35, v35
    v_cvt_pk_bf16_f32 v64, v32, v33
    s_setprio 2
    v_exp_f32 v36, v36
    v_exp_f32 v37, v37
    v_cvt_pk_bf16_f32 v65, v34, v35
    v_exp_f32 v38, v38
    v_exp_f32 v39, v39
    v_cvt_pk_bf16_f32 v66, v36, v37
    v_exp_f32 v40, v40
    v_exp_f32 v41, v41
    v_cvt_pk_bf16_f32 v67, v38, v39
    v_exp_f32 v42, v42
    v_exp_f32 v43, v43
    v_cvt_pk_bf16_f32 v68, v40, v41
    v_exp_f32 v44, v44
    v_exp_f32 v45, v45
    v_cvt_pk_bf16_f32 v69, v42, v43
    v_exp_f32 v46, v46
    v_exp_f32 v47, v47
    v_cvt_pk_bf16_f32 v70, v44, v45
    v_cvt_pk_bf16_f32 v71, v46, v47
    s_setprio 0
    s_waitcnt lgkmcnt(0)
    v_mfma_f32_32x32x16_bf16 v[32:47], v[92:95], v[4:7], v[16:31]
    buffer_load_dwordx4 v1, s[8:11], s12 offen offset:1024 sc1 lds
    s_add_u32 s12, s12, 16384
    v_mfma_f32_32x32x16_bf16 v[72:87], v[108:111], v[64:67], v[72:87]
    v_mfma_f32_32x32x16_bf16 v[72:87], v[112:115], v[68:71], v[72:87]
    ds_read_b128 v[100:103], v128 offset:20480
    ds_read_b128 v[104:107], v128 offset:21504
    v_mfma_f32_32x32x16_bf16 v[32:47], v[96:99], v[8:11], v[32:47]
    ds_read_b128 v[108:111], v128 offset:18432
    ds_read_b128 v[112:115], v128 offset:19456
    v_smfmac_f32_16x16x64_bf16 v[88:91], v[124:127], v[64:71], v15
    buffer_store_dwordx2 v[202:203], v216, s[8:11], 0 offen offset:512 sc1
    v_exp_f32 v48, v48
    v_exp_f32 v49, v49
    v_exp_f32 v50, v50
    v_exp_f32 v51, v51
    v_cvt_pk_bf16_f32 v64, v48, v49
    s_setprio 2
    v_exp_f32 v52, v52
    v_exp_f32 v53, v53
    v_cvt_pk_bf16_f32 v65, v50, v51
    v_exp_f32 v54, v54
    v_exp_f32 v55, v55
    v_cvt_pk_bf16_f32 v66, v52, v53
    v_exp_f32 v56, v56
    v_exp_f32 v57, v57
    v_cvt_pk_bf16_f32 v67, v54, v55
    v_exp_f32 v58, v58
    v_exp_f32 v59, v59
    v_cvt_pk_bf16_f32 v68, v56, v57
    v_exp_f32 v60, v60
    v_exp_f32 v61, v61
    v_cvt_pk_bf16_f32 v69, v58, v59
    v_exp_f32 v62, v62
    v_exp_f32 v63, v63
    v_cvt_pk_bf16_f32 v70, v60, v61
    v_cvt_pk_bf16_f32 v71, v62, v63
    s_setprio 0
    s_waitcnt lgkmcnt(0)
    v_mfma_f32_32x32x16_bf16 v[48:63], v[100:103], v[4:7], v[16:31]
    s_mov_b32 m0, s49
    s_add_u32 s49, s49, 8192
    buffer_load_dwordx4 v129, s[44:47], s48 offen lds
    s_add_u32 s48, s48, 131072
    v_mfma_f32_32x32x16_bf16 v[72:87], v[116:119], v[64:67], v[72:87]
    v_mfma_f32_32x32x16_bf16 v[72:87], v[120:123], v[68:71], v[72:87]
    ds_read_b128 v[92:95], v128 offset:24576
    ds_read_b128 v[96:99], v128 offset:25600
    v_mfma_f32_32x32x16_bf16 v[48:63], v[104:107], v[8:11], v[48:63]
    ds_read_b128 v[116:119], v128 offset:22528
    ds_read_b128 v[120:123], v128 offset:23552
    v_smfmac_f32_16x16x64_bf16 v[88:91], v[124:127], v[64:71], v15
    buffer_store_dwordx2 v[204:205], v216, s[8:11], 0 offen offset:1024 sc1
    v_exp_f32 v32, v32
    v_exp_f32 v33, v33
    v_exp_f32 v34, v34
    v_exp_f32 v35, v35
    v_cvt_pk_bf16_f32 v64, v32, v33
    s_setprio 2
    v_exp_f32 v36, v36
    v_exp_f32 v37, v37
    v_cvt_pk_bf16_f32 v65, v34, v35
    v_exp_f32 v38, v38
    v_exp_f32 v39, v39
    v_cvt_pk_bf16_f32 v66, v36, v37
    v_exp_f32 v40, v40
    v_exp_f32 v41, v41
    v_cvt_pk_bf16_f32 v67, v38, v39
    v_exp_f32 v42, v42
    v_exp_f32 v43, v43
    v_cvt_pk_bf16_f32 v68, v40, v41
    v_exp_f32 v44, v44
    v_exp_f32 v45, v45
    v_cvt_pk_bf16_f32 v69, v42, v43
    v_exp_f32 v46, v46
    v_exp_f32 v47, v47
    v_cvt_pk_bf16_f32 v70, v44, v45
    v_cvt_pk_bf16_f32 v71, v46, v47
    s_setprio 0
    s_waitcnt lgkmcnt(0)
    v_mfma_f32_32x32x16_bf16 v[32:47], v[92:95], v[4:7], v[16:31]
    v_mfma_f32_32x32x16_bf16 v[72:87], v[108:111], v[64:67], v[72:87]
    v_mfma_f32_32x32x16_bf16 v[72:87], v[112:115], v[68:71], v[72:87]
    ds_read_b128 v[100:103], v128 offset:28672
    ds_read_b128 v[104:107], v128 offset:29696
    v_mfma_f32_32x32x16_bf16 v[32:47], v[96:99], v[8:11], v[32:47]
    ds_read_b128 v[108:111], v128 offset:26624
    ds_read_b128 v[112:115], v128 offset:27648
    v_smfmac_f32_16x16x64_bf16 v[88:91], v[124:127], v[64:71], v15
    buffer_store_dwordx2 v[206:207], v216, s[8:11], 0 offen offset:1536 sc1
    s_cbranch_vccnz SKB_first_5
    s_waitcnt vmcnt(7)
    s_barrier
SKB_first_5:
    v_exp_f32 v48, v48
    v_exp_f32 v49, v49
    v_exp_f32 v50, v50
    v_exp_f32 v51, v51
    v_cvt_pk_bf16_f32 v64, v48, v49
    s_setprio 2
    v_exp_f32 v52, v52
    v_exp_f32 v53, v53
    v_cvt_pk_bf16_f32 v65, v50, v51
    v_exp_f32 v54, v54
    v_exp_f32 v55, v55
    v_cvt_pk_bf16_f32 v66, v52, v53
    v_exp_f32 v56, v56
    v_exp_f32 v57, v57
    v_cvt_pk_bf16_f32 v67, v54, v55
    v_exp_f32 v58, v58
    v_exp_f32 v59, v59
    v_cvt_pk_bf16_f32 v68, v56, v57
    v_exp_f32 v60, v60
    v_exp_f32 v61, v61
    v_cvt_pk_bf16_f32 v69, v58, v59
    v_exp_f32 v62, v62
    v_exp_f32 v63, v63
    v_cvt_pk_bf16_f32 v70, v60, v61
    v_cvt_pk_bf16_f32 v71, v62, v63
    s_cbranch_vccz SKA_first_5
    s_waitcnt vmcnt(7)
    s_barrier
SKA_first_5:
    s_setprio 0
    s_waitcnt lgkmcnt(0)
    v_mfma_f32_32x32x16_bf16 v[48:63], v[100:103], v[4:7], v[16:31]
    s_add_u32 m0, s13, 0
    s_nop 0
    buffer_load_dwordx4 v1, s[8:11], s12 offen sc1 lds
    v_mfma_f32_32x32x16_bf16 v[72:87], v[116:119], v[64:67], v[72:87]
    v_mfma_f32_32x32x16_bf16 v[72:87], v[120:123], v[68:71], v[72:87]
    ds_read_b128 v[92:95], v128 offset:32768
    ds_read_b128 v[96:99], v128 offset:33792
    v_mfma_f32_32x32x16_bf16 v[48:63], v[104:107], v[8:11], v[48:63]
    ds_read_b128 v[116:119], v128 offset:30720
    ds_read_b128 v[120:123], v128 offset:31744
    v_smfmac_f32_16x16x64_bf16 v[88:91], v[124:127], v[64:71], v15
    buffer_store_dwordx2 v[208:209], v216, s[8:11], 0 offen offset:2048 sc1
    v_exp_f32 v32, v32
    v_exp_f32 v33, v33
    v_exp_f32 v34, v34
    v_exp_f32 v35, v35
    v_cvt_pk_bf16_f32 v64, v32, v33
    s_setprio 2
    v_exp_f32 v36, v36
    v_exp_f32 v37, v37
    v_cvt_pk_bf16_f32 v65, v34, v35
    v_exp_f32 v38, v38
    v_exp_f32 v39, v39
    v_cvt_pk_bf16_f32 v66, v36, v37
    v_exp_f32 v40, v40
    v_exp_f32 v41, v41
    v_cvt_pk_bf16_f32 v67, v38, v39
    v_exp_f32 v42, v42
    v_exp_f32 v43, v43
    v_cvt_pk_bf16_f32 v68, v40, v41
    v_exp_f32 v44, v44
    v_exp_f32 v45, v45
    v_cvt_pk_bf16_f32 v69, v42, v43
    v_exp_f32 v46, v46
    v_exp_f32 v47, v47
    v_cvt_pk_bf16_f32 v70, v44, v45
    v_cvt_pk_bf16_f32 v71, v46, v47
    s_setprio 0
    s_waitcnt lgkmcnt(0)
    v_mfma_f32_32x32x16_bf16 v[32:47], v[92:95], v[4:7], v[16:31]
    buffer_load_dwordx4 v1, s[8:11], s12 offen offset:1024 sc1 lds
    s_add_u32 s12, s12, 16384
    v_mfma_f32_32x32x16_bf16 v[72:87], v[108:111], v[64:67], v[72:87]
    v_mfma_f32_32x32x16_bf16 v[72:87], v[112:115], v[68:71], v[72:87]
    ds_read_b128 v[100:103], v128 offset:36864
    ds_read_b128 v[104:107], v128 offset:37888
    v_mfma_f32_32x32x16_bf16 v[32:47], v[96:99], v[8:11], v[32:47]
    ds_read_b128 v[108:111], v128 offset:34816
    ds_read_b128 v[112:115], v128 offset:35840
    v_smfmac_f32_16x16x64_bf16 v[88:91], v[124:127], v[64:71], v15
    buffer_store_dwordx2 v[210:211], v216, s[8:11], 0 offen offset:2560 sc1
    v_exp_f32 v48, v48
    v_exp_f32 v49, v49
    v_exp_f32 v50, v50
    v_exp_f32 v51, v51
    v_cvt_pk_bf16_f32 v64, v48, v49
    s_setprio 2
    v_exp_f32 v52, v52
    v_exp_f32 v53, v53
    v_cvt_pk_bf16_f32 v65, v50, v51
    v_exp_f32 v54, v54
    v_exp_f32 v55, v55
    v_cvt_pk_bf16_f32 v66, v52, v53
    v_exp_f32 v56, v56
    v_exp_f32 v57, v57
    v_cvt_pk_bf16_f32 v67, v54, v55
    v_exp_f32 v58, v58
    v_exp_f32 v59, v59
    v_cvt_pk_bf16_f32 v68, v56, v57
    v_exp_f32 v60, v60
    v_exp_f32 v61, v61
    v_cvt_pk_bf16_f32 v69, v58, v59
    v_exp_f32 v62, v62
    v_exp_f32 v63, v63
    v_cvt_pk_bf16_f32 v70, v60, v61
    v_cvt_pk_bf16_f32 v71, v62, v63
    s_setprio 0
    s_waitcnt lgkmcnt(0)
    v_mfma_f32_32x32x16_bf16 v[48:63], v[100:103], v[4:7], v[16:31]
    s_mov_b32 m0, s49
    s_add_u32 s49, s49, 8192
    buffer_load_dwordx4 v129, s[44:47], s48 offen lds
    s_add_u32 s48, s48, 131072
    v_mfma_f32_32x32x16_bf16 v[72:87], v[116:119], v[64:67], v[72:87]
    v_mfma_f32_32x32x16_bf16 v[72:87], v[120:123], v[68:71], v[72:87]
    ds_read_b128 v[92:95], v128 offset:40960
    ds_read_b128 v[96:99], v128 offset:41984
    v_mfma_f32_32x32x16_bf16 v[48:63], v[104:107], v[8:11], v[48:63]
    ds_read_b128 v[116:119], v128 offset:38912
    ds_read_b128 v[120:123], v128 offset:39936
    v_smfmac_f32_16x16x64_bf16 v[88:91], v[124:127], v[64:71], v15
    buffer_store_dwordx2 v[212:213], v216, s[8:11], 0 offen offset:3072 sc1
    v_exp_f32 v32, v32
    v_exp_f32 v33, v33
    v_exp_f32 v34, v34
    v_exp_f32 v35, v35
    v_cvt_pk_bf16_f32 v64, v32, v33
    s_setprio 2
    v_exp_f32 v36, v36
    v_exp_f32 v37, v37
    v_cvt_pk_bf16_f32 v65, v34, v35
    v_exp_f32 v38, v38
    v_exp_f32 v39, v39
    v_cvt_pk_bf16_f32 v66, v36, v37
    v_exp_f32 v40, v40
    v_exp_f32 v41, v41
    v_cvt_pk_bf16_f32 v67, v38, v39
    v_exp_f32 v42, v42
    v_exp_f32 v43, v43
    v_cvt_pk_bf16_f32 v68, v40, v41
    v_exp_f32 v44, v44
    v_exp_f32 v45, v45
    v_cvt_pk_bf16_f32 v69, v42, v43
    v_exp_f32 v46, v46
    v_exp_f32 v47, v47
    v_cvt_pk_bf16_f32 v70, v44, v45
    v_cvt_pk_bf16_f32 v71, v46, v47
    s_setprio 0
    s_waitcnt lgkmcnt(0)
    v_mfma_f32_32x32x16_bf16 v[32:47], v[92:95], v[4:7], v[16:31]
    v_mfma_f32_32x32x16_bf16 v[72:87], v[108:111], v[64:67], v[72:87]
    v_mfma_f32_32x32x16_bf16 v[72:87], v[112:115], v[68:71], v[72:87]
    ds_read_b128 v[100:103], v128 offset:45056
    ds_read_b128 v[104:107], v128 offset:46080
    v_mfma_f32_32x32x16_bf16 v[32:47], v[96:99], v[8:11], v[32:47]
    ds_read_b128 v[108:111], v128 offset:43008
    ds_read_b128 v[112:115], v128 offset:44032
    v_smfmac_f32_16x16x64_bf16 v[88:91], v[124:127], v[64:71], v15
    buffer_store_dwordx2 v[214:215], v216, s[8:11], 0 offen offset:3584 sc1
    s_cbranch_vccnz SKB_first_9
    s_waitcnt vmcnt(11)
    s_barrier
SKB_first_9:
    v_exp_f32 v48, v48
    v_exp_f32 v49, v49
    v_exp_f32 v50, v50
    v_exp_f32 v51, v51
    v_cvt_pk_bf16_f32 v64, v48, v49
    s_setprio 2
    v_exp_f32 v52, v52
    v_exp_f32 v53, v53
    v_cvt_pk_bf16_f32 v65, v50, v51
    v_exp_f32 v54, v54
    v_exp_f32 v55, v55
    v_cvt_pk_bf16_f32 v66, v52, v53
    v_exp_f32 v56, v56
    v_exp_f32 v57, v57
    v_cvt_pk_bf16_f32 v67, v54, v55
    v_exp_f32 v58, v58
    v_exp_f32 v59, v59
    v_cvt_pk_bf16_f32 v68, v56, v57
    v_exp_f32 v60, v60
    v_exp_f32 v61, v61
    v_cvt_pk_bf16_f32 v69, v58, v59
    v_exp_f32 v62, v62
    v_exp_f32 v63, v63
    v_cvt_pk_bf16_f32 v70, v60, v61
    v_cvt_pk_bf16_f32 v71, v62, v63
    s_cbranch_vccz SKA_first_9
    s_waitcnt vmcnt(11)
    s_barrier
SKA_first_9:
    s_setprio 0
    s_waitcnt lgkmcnt(0)
    v_mfma_f32_32x32x16_bf16 v[48:63], v[100:103], v[4:7], v[16:31]
    s_add_u32 m0, s13, 16384
    s_nop 0
    buffer_load_dwordx4 v1, s[8:11], s12 offen sc1 lds
    v_mfma_f32_32x32x16_bf16 v[72:87], v[116:119], v[64:67], v[72:87]
    v_mfma_f32_32x32x16_bf16 v[72:87], v[120:123], v[68:71], v[72:87]
    ds_read_b128 v[92:95], v128 offset:49152
    ds_read_b128 v[96:99], v128 offset:50176
    v_mfma_f32_32x32x16_bf16 v[48:63], v[104:107], v[8:11], v[48:63]
    ds_read_b128 v[116:119], v128 offset:47104
    ds_read_b128 v[120:123], v128 offset:48128
    v_smfmac_f32_16x16x64_bf16 v[88:91], v[124:127], v[64:71], v15
    v_exp_f32 v32, v32
    v_exp_f32 v33, v33
    v_exp_f32 v34, v34
    v_exp_f32 v35, v35
    v_cvt_pk_bf16_f32 v64, v32, v33
    s_setprio 2
    v_exp_f32 v36, v36
    v_exp_f32 v37, v37
    v_cvt_pk_bf16_f32 v65, v34, v35
    v_exp_f32 v38, v38
    v_exp_f32 v39, v39
    v_cvt_pk_bf16_f32 v66, v36, v37
    v_exp_f32 v40, v40
    v_exp_f32 v41, v41
    v_cvt_pk_bf16_f32 v67, v38, v39
    v_exp_f32 v42, v42
    v_exp_f32 v43, v43
    v_cvt_pk_bf16_f32 v68, v40, v41
    v_exp_f32 v44, v44
    v_exp_f32 v45, v45
    v_cvt_pk_bf16_f32 v69, v42, v43
    v_exp_f32 v46, v46
    v_exp_f32 v47, v47
    v_cvt_pk_bf16_f32 v70, v44, v45
    v_cvt_pk_bf16_f32 v71, v46, v47
    s_setprio 0
    s_waitcnt lgkmcnt(0)
    v_mfma_f32_32x32x16_bf16 v[32:47], v[92:95], v[4:7], v[16:31]
    buffer_load_dwordx4 v1, s[8:11], s12 offen offset:1024 sc1 lds
    s_add_u32 s12, s12, 16384
    v_mfma_f32_32x32x16_bf16 v[72:87], v[108:111], v[64:67], v[72:87]
    v_mfma_f32_32x32x16_bf16 v[72:87], v[112:115], v[68:71], v[72:87]
    ds_read_b128 v[100:103], v128 offset:53248
    ds_read_b128 v[104:107], v128 offset:54272
    v_mfma_f32_32x32x16_bf16 v[32:47], v[96:99], v[8:11], v[32:47]
    ds_read_b128 v[108:111], v128 offset:51200
    ds_read_b128 v[112:115], v128 offset:52224
    v_smfmac_f32_16x16x64_bf16 v[88:91], v[124:127], v[64:71], v15
    v_exp_f32 v48, v48
    v_exp_f32 v49, v49
    v_exp_f32 v50, v50
    v_exp_f32 v51, v51
    v_cvt_pk_bf16_f32 v64, v48, v49
    s_setprio 2
    v_exp_f32 v52, v52
    v_exp_f32 v53, v53
    v_cvt_pk_bf16_f32 v65, v50, v51
    v_exp_f32 v54, v54
    v_exp_f32 v55, v55
    v_cvt_pk_bf16_f32 v66, v52, v53
    v_exp_f32 v56, v56
    v_exp_f32 v57, v57
    v_cvt_pk_bf16_f32 v67, v54, v55
    v_exp_f32 v58, v58
    v_exp_f32 v59, v59
    v_cvt_pk_bf16_f32 v68, v56, v57
    v_exp_f32 v60, v60
    v_exp_f32 v61, v61
    v_cvt_pk_bf16_f32 v69, v58, v59
    v_exp_f32 v62, v62
    v_exp_f32 v63, v63
    v_cvt_pk_bf16_f32 v70, v60, v61
    v_cvt_pk_bf16_f32 v71, v62, v63
    s_setprio 0
    s_waitcnt lgkmcnt(0)
    v_mfma_f32_32x32x16_bf16 v[48:63], v[100:103], v[4:7], v[16:31]
    s_mov_b32 m0, s49
    s_add_u32 s49, s49, 8192
    buffer_load_dwordx4 v129, s[44:47], s48 offen lds
    s_add_u32 s48, s48, 131072
    v_mfma_f32_32x32x16_bf16 v[72:87], v[116:119], v[64:67], v[72:87]
    v_mfma_f32_32x32x16_bf16 v[72:87], v[120:123], v[68:71], v[72:87]
    ds_read_b128 v[92:95], v128 offset:57344
    ds_read_b128 v[96:99], v128 offset:58368
    v_mfma_f32_32x32x16_bf16 v[48:63], v[104:107], v[8:11], v[48:63]
    ds_read_b128 v[116:119], v128 offset:55296
    ds_read_b128 v[120:123], v128 offset:56320
    v_smfmac_f32_16x16x64_bf16 v[88:91], v[124:127], v[64:71], v15
    v_exp_f32 v32, v32
    v_exp_f32 v33, v33
    v_exp_f32 v34, v34
    v_exp_f32 v35, v35
    v_cvt_pk_bf16_f32 v64, v32, v33
    s_setprio 2
    v_exp_f32 v36, v36
    v_exp_f32 v37, v37
    v_cvt_pk_bf16_f32 v65, v34, v35
    v_exp_f32 v38, v38
    v_exp_f32 v39, v39
    v_cvt_pk_bf16_f32 v66, v36, v37
    v_exp_f32 v40, v40
    v_exp_f32 v41, v41
    v_cvt_pk_bf16_f32 v67, v38, v39
    v_exp_f32 v42, v42
    v_exp_f32 v43, v43
    v_cvt_pk_bf16_f32 v68, v40, v41
    v_exp_f32 v44, v44
    v_exp_f32 v45, v45
    v_cvt_pk_bf16_f32 v69, v42, v43
    v_exp_f32 v46, v46
    v_exp_f32 v47, v47
    v_cvt_pk_bf16_f32 v70, v44, v45
    v_cvt_pk_bf16_f32 v71, v46, v47
    s_setprio 0
    s_waitcnt lgkmcnt(0)
    v_mfma_f32_32x32x16_bf16 v[32:47], v[92:95], v[4:7], v[16:31]
    v_mfma_f32_32x32x16_bf16 v[72:87], v[108:111], v[64:67], v[72:87]
    v_mfma_f32_32x32x16_bf16 v[72:87], v[112:115], v[68:71], v[72:87]
    ds_read_b128 v[100:103], v128 offset:61440
    ds_read_b128 v[104:107], v128 offset:62464
    v_mfma_f32_32x32x16_bf16 v[32:47], v[96:99], v[8:11], v[32:47]
    ds_read_b128 v[108:111], v128 offset:59392
    ds_read_b128 v[112:115], v128 offset:60416
    v_smfmac_f32_16x16x64_bf16 v[88:91], v[124:127], v[64:71], v15
    s_waitcnt vmcnt(3)
    s_cbranch_vccnz SKB_first_13
    s_nop 0
    s_barrier
SKB_first_13:
    v_exp_f32 v48, v48
    v_exp_f32 v49, v49
    v_exp_f32 v50, v50
    v_exp_f32 v51, v51
    v_cvt_pk_bf16_f32 v64, v48, v49
    s_setprio 2
    v_exp_f32 v52, v52
    v_exp_f32 v53, v53
    v_cvt_pk_bf16_f32 v65, v50, v51
    v_exp_f32 v54, v54
    v_exp_f32 v55, v55
    v_cvt_pk_bf16_f32 v66, v52, v53
    v_exp_f32 v56, v56
    v_exp_f32 v57, v57
    v_cvt_pk_bf16_f32 v67, v54, v55
    v_exp_f32 v58, v58
    v_exp_f32 v59, v59
    v_cvt_pk_bf16_f32 v68, v56, v57
    v_exp_f32 v60, v60
    v_exp_f32 v61, v61
    v_cvt_pk_bf16_f32 v69, v58, v59
    v_exp_f32 v62, v62
    v_exp_f32 v63, v63
    v_cvt_pk_bf16_f32 v70, v60, v61
    v_cvt_pk_bf16_f32 v71, v62, v63
    s_cbranch_vccz SKA_first_13
    s_nop 0
    s_barrier
SKA_first_13:
    s_setprio 0
    s_waitcnt lgkmcnt(0)
    v_mfma_f32_32x32x16_bf16 v[48:63], v[100:103], v[4:7], v[16:31]
    s_add_u32 m0, s13, 32768
    s_nop 0
    buffer_load_dwordx4 v1, s[8:11], s12 offen sc1 lds
    v_mfma_f32_32x32x16_bf16 v[72:87], v[116:119], v[64:67], v[72:87]
    v_mfma_f32_32x32x16_bf16 v[72:87], v[120:123], v[68:71], v[72:87]
    ds_read_b128 v[92:95], v128 offset:0
    ds_read_b128 v[96:99], v128 offset:1024
    v_mfma_f32_32x32x16_bf16 v[48:63], v[104:107], v[8:11], v[48:63]
    ds_read_b128 v[116:119], v128 offset:63488
    ds_read_b128 v[120:123], v128 offset:64512
    v_smfmac_f32_16x16x64_bf16 v[88:91], v[124:127], v[64:71], v15
    v_exp_f32 v32, v32
    v_exp_f32 v33, v33
    v_exp_f32 v34, v34
    v_exp_f32 v35, v35
    v_cvt_pk_bf16_f32 v64, v32, v33
    s_setprio 2
    v_exp_f32 v36, v36
    v_exp_f32 v37, v37
    v_cvt_pk_bf16_f32 v65, v34, v35
    v_exp_f32 v38, v38
    v_exp_f32 v39, v39
    v_cvt_pk_bf16_f32 v66, v36, v37
    v_exp_f32 v40, v40
    v_exp_f32 v41, v41
    v_cvt_pk_bf16_f32 v67, v38, v39
    v_exp_f32 v42, v42
    v_exp_f32 v43, v43
    v_cvt_pk_bf16_f32 v68, v40, v41
    v_exp_f32 v44, v44
    v_exp_f32 v45, v45
    v_cvt_pk_bf16_f32 v69, v42, v43
    v_exp_f32 v46, v46
    v_exp_f32 v47, v47
    v_cvt_pk_bf16_f32 v70, v44, v45
    v_cvt_pk_bf16_f32 v71, v46, v47
    s_setprio 0
    s_waitcnt lgkmcnt(0)
    v_mfma_f32_32x32x16_bf16 v[32:47], v[92:95], v[4:7], v[16:31]
    buffer_load_dwordx4 v1, s[8:11], s12 offen offset:1024 sc1 lds
    s_add_u32 s12, s12, 16384
    v_mfma_f32_32x32x16_bf16 v[72:87], v[108:111], v[64:67], v[72:87]
    v_mfma_f32_32x32x16_bf16 v[72:87], v[112:115], v[68:71], v[72:87]
    ds_read_b128 v[100:103], v128 offset:4096
    ds_read_b128 v[104:107], v128 offset:5120
    v_mfma_f32_32x32x16_bf16 v[32:47], v[96:99], v[8:11], v[32:47]
    ds_read_b128 v[108:111], v128 offset:2048
    ds_read_b128 v[112:115], v128 offset:3072
    v_smfmac_f32_16x16x64_bf16 v[88:91], v[124:127], v[64:71], v15
    s_mov_b64 exec, 1
    v_mov_b32 v12, 1
    buffer_store_dword v12, v2, s[8:11], s57 offen sc1
    s_mov_b64 exec, -1
    v_exp_f32 v48, v48
    v_exp_f32 v49, v49
    v_exp_f32 v50, v50
    v_exp_f32 v51, v51
    v_cvt_pk_bf16_f32 v64, v48, v49
    s_setprio 2
    v_exp_f32 v52, v52
    v_exp_f32 v53, v53
    v_cvt_pk_bf16_f32 v65, v50, v51
    v_exp_f32 v54, v54
    v_exp_f32 v55, v55
    v_cvt_pk_bf16_f32 v66, v52, v53
    v_exp_f32 v56, v56
    v_exp_f32 v57, v57
    v_cvt_pk_bf16_f32 v67, v54, v55
    v_exp_f32 v58, v58
    v_exp_f32 v59, v59
    v_cvt_pk_bf16_f32 v68, v56, v57
    v_exp_f32 v60, v60
    v_exp_f32 v61, v61
    v_cvt_pk_bf16_f32 v69, v58, v59
    v_exp_f32 v62, v62
    v_exp_f32 v63, v63
    v_cvt_pk_bf16_f32 v70, v60, v61
    v_cvt_pk_bf16_f32 v71, v62, v63
P2_LOOP:
    s_setprio 0
    s_waitcnt lgkmcnt(0)
    v_mfma_f32_32x32x16_bf16 v[48:63], v[100:103], v[4:7], v[16:31]
    s_mov_b32 m0, s49
    s_add_u32 s49, s49, 8192
    buffer_load_dwordx4 v129, s[44:47], s48 offen lds
    s_add_u32 s48, s48, 131072
    v_mfma_f32_32x32x16_bf16 v[72:87], v[116:119], v[64:67], v[72:87]
    v_mfma_f32_32x32x16_bf16 v[72:87], v[120:123], v[68:71], v[72:87]
    ds_read_b128 v[92:95], v128 offset:8192
    ds_read_b128 v[96:99], v128 offset:9216
    v_mfma_f32_32x32x16_bf16 v[48:63], v[104:107], v[8:11], v[48:63]
    ds_read_b128 v[116:119], v128 offset:6144
    ds_read_b128 v[120:123], v128 offset:7168
    v_smfmac_f32_16x16x64_bf16 v[88:91], v[124:127], v[64:71], v15
    v_exp_f32 v32, v32
    v_exp_f32 v33, v33
    v_exp_f32 v34, v34
    v_exp_f32 v35, v35
    v_cvt_pk_bf16_f32 v64, v32, v33
    s_setprio 2
    v_exp_f32 v36, v36
    v_exp_f32 v37, v37
    v_cvt_pk_bf16_f32 v65, v34, v35
    v_exp_f32 v38, v38
    v_exp_f32 v39, v39
    v_cvt_pk_bf16_f32 v66, v36, v37
    v_exp_f32 v40, v40
    v_exp_f32 v41, v41
    v_cvt_pk_bf16_f32 v67, v38, v39
    v_exp_f32 v42, v42
    v_exp_f32 v43, v43
    v_cvt_pk_bf16_f32 v68, v40, v41
    v_exp_f32 v44, v44
    v_exp_f32 v45, v45
    v_cvt_pk_bf16_f32 v69, v42, v43
    v_exp_f32 v46, v46
    v_exp_f32 v47, v47
    v_cvt_pk_bf16_f32 v70, v44, v45
    v_cvt_pk_bf16_f32 v71, v46, v47
    s_setprio 0
    s_waitcnt lgkmcnt(0)
    v_mfma_f32_32x32x16_bf16 v[32:47], v[92:95], v[4:7], v[16:31]
    v_mfma_f32_32x32x16_bf16 v[72:87], v[108:111], v[64:67], v[72:87]
    v_mfma_f32_32x32x16_bf16 v[72:87], v[112:115], v[68:71], v[72:87]
    ds_read_b128 v[100:103], v128 offset:12288
    ds_read_b128 v[104:107], v128 offset:13312
    v_mfma_f32_32x32x16_bf16 v[32:47], v[96:99], v[8:11], v[32:47]
    ds_read_b128 v[108:111], v128 offset:10240
    ds_read_b128 v[112:115], v128 offset:11264
    v_smfmac_f32_16x16x64_bf16 v[88:91], v[124:127], v[64:71], v15
    s_cbranch_vccnz SKB_mid_1
    s_waitcnt vmcnt(4)
    s_barrier
SKB_mid_1:
    v_exp_f32 v48, v48
    v_exp_f32 v49, v49
    v_exp_f32 v50, v50
    v_exp_f32 v51, v51
    v_cvt_pk_bf16_f32 v64, v48, v49
    s_setprio 2
    v_exp_f32 v52, v52
    v_exp_f32 v53, v53
    v_cvt_pk_bf16_f32 v65, v50, v51
    v_exp_f32 v54, v54
    v_exp_f32 v55, v55
    v_cvt_pk_bf16_f32 v66, v52, v53
    v_exp_f32 v56, v56
    v_exp_f32 v57, v57
    v_cvt_pk_bf16_f32 v67, v54, v55
    v_exp_f32 v58, v58
    v_exp_f32 v59, v59
    v_cvt_pk_bf16_f32 v68, v56, v57
    v_exp_f32 v60, v60
    v_exp_f32 v61, v61
    v_cvt_pk_bf16_f32 v69, v58, v59
    v_exp_f32 v62, v62
    v_exp_f32 v63, v63
    v_cvt_pk_bf16_f32 v70, v60, v61
    v_cvt_pk_bf16_f32 v71, v62, v63
    s_cbranch_vccz SKA_mid_1
    s_waitcnt vmcnt(4)
    s_barrier
SKA_mid_1:
    s_setprio 0
    s_waitcnt lgkmcnt(0)
    v_mfma_f32_32x32x16_bf16 v[48:63], v[100:103], v[4:7], v[16:31]
    s_add_u32 m0, s13, 49152
    s_nop 0
    buffer_load_dwordx4 v1, s[8:11], s12 offen sc1 lds
    v_mfma_f32_32x32x16_bf16 v[72:87], v[116:119], v[64:67], v[72:87]
    v_mfma_f32_32x32x16_bf16 v[72:87], v[120:123], v[68:71], v[72:87]
    ds_read_b128 v[92:95], v128 offset:16384
    ds_read_b128 v[96:99], v128 offset:17408
    v_mfma_f32_32x32x16_bf16 v[48:63], v[104:107], v[8:11], v[48:63]
    ds_read_b128 v[116:119], v128 offset:14336
    ds_read_b128 v[120:123], v128 offset:15360
    v_smfmac_f32_16x16x64_bf16 v[88:91], v[124:127], v[64:71], v15
    v_exp_f32 v32, v32
    v_exp_f32 v33, v33
    v_exp_f32 v34, v34
    v_exp_f32 v35, v35
    v_cvt_pk_bf16_f32 v64, v32, v33
    s_setprio 2
    v_exp_f32 v36, v36
    v_exp_f32 v37, v37
    v_cvt_pk_bf16_f32 v65, v34, v35
    v_exp_f32 v38, v38
    v_exp_f32 v39, v39
    v_cvt_pk_bf16_f32 v66, v36, v37
    v_exp_f32 v40, v40
    v_exp_f32 v41, v41
    v_cvt_pk_bf16_f32 v67, v38, v39
    v_exp_f32 v42, v42
    v_exp_f32 v43, v43
    v_cvt_pk_bf16_f32 v68, v40, v41
    v_exp_f32 v44, v44
    v_exp_f32 v45, v45
    v_cvt_pk_bf16_f32 v69, v42, v43
    v_exp_f32 v46, v46
    v_exp_f32 v47, v47
    v_cvt_pk_bf16_f32 v70, v44, v45
    v_cvt_pk_bf16_f32 v71, v46, v47
    s_setprio 0
    s_waitcnt lgkmcnt(0)
    v_mfma_f32_32x32x16_bf16 v[32:47], v[92:95], v[4:7], v[16:31]
    buffer_load_dwordx4 v1, s[8:11], s12 offen offset:1024 sc1 lds
    s_add_u32 s12, s12, 16384
    v_mfma_f32_32x32x16_bf16 v[72:87], v[108:111], v[64:67], v[72:87]
    v_mfma_f32_32x32x16_bf16 v[72:87], v[112:115], v[68:71], v[72:87]
    ds_read_b128 v[100:103], v128 offset:20480
    ds_read_b128 v[104:107], v128 offset:21504
    v_mfma_f32_32x32x16_bf16 v[32:47], v[96:99], v[8:11], v[32:47]
    ds_read_b128 v[108:111], v128 offset:18432
    ds_read_b128 v[112:115], v128 offset:19456
    v_smfmac_f32_16x16x64_bf16 v[88:91], v[124:127], v[64:71], v15
    v_exp_f32 v48, v48
    v_exp_f32 v49, v49
    v_exp_f32 v50, v50
    v_exp_f32 v51, v51
    v_cvt_pk_bf16_f32 v64, v48, v49
    s_setprio 2
    v_exp_f32 v52, v52
    v_exp_f32 v53, v53
    v_cvt_pk_bf16_f32 v65, v50, v51
    v_exp_f32 v54, v54
    v_exp_f32 v55, v55
    v_cvt_pk_bf16_f32 v66, v52, v53
    v_exp_f32 v56, v56
    v_exp_f32 v57, v57
    v_cvt_pk_bf16_f32 v67, v54, v55
    v_exp_f32 v58, v58
    v_exp_f32 v59, v59
    v_cvt_pk_bf16_f32 v68, v56, v57
    v_exp_f32 v60, v60
    v_exp_f32 v61, v61
    v_cvt_pk_bf16_f32 v69, v58, v59
    v_exp_f32 v62, v62
    v_exp_f32 v63, v63
    v_cvt_pk_bf16_f32 v70, v60, v61
    v_cvt_pk_bf16_f32 v71, v62, v63
    s_setprio 0
    s_waitcnt lgkmcnt(0)
    v_mfma_f32_32x32x16_bf16 v[48:63], v[100:103], v[4:7], v[16:31]
    s_mov_b32 m0, s49
    s_add_u32 s49, s49, 8192
    buffer_load_dwordx4 v129, s[44:47], s48 offen lds
    s_add_u32 s48, s48, 131072
    v_mfma_f32_32x32x16_bf16 v[72:87], v[116:119], v[64:67], v[72:87]
    v_mfma_f32_32x32x16_bf16 v[72:87], v[120:123], v[68:71], v[72:87]
    ds_read_b128 v[92:95], v128 offset:24576
    ds_read_b128 v[96:99], v128 offset:25600
    v_mfma_f32_32x32x16_bf16 v[48:63], v[104:107], v[8:11], v[48:63]
    ds_read_b128 v[116:119], v128 offset:22528
    ds_read_b128 v[120:123], v128 offset:23552
    v_smfmac_f32_16x16x64_bf16 v[88:91], v[124:127], v[64:71], v15
    v_exp_f32 v32, v32
    v_exp_f32 v33, v33
    v_exp_f32 v34, v34
    v_exp_f32 v35, v35
    v_cvt_pk_bf16_f32 v64, v32, v33
    s_setprio 2
    v_exp_f32 v36, v36
    v_exp_f32 v37, v37
    v_cvt_pk_bf16_f32 v65, v34, v35
    v_exp_f32 v38, v38
    v_exp_f32 v39, v39
    v_cvt_pk_bf16_f32 v66, v36, v37
    v_exp_f32 v40, v40
    v_exp_f32 v41, v41
    v_cvt_pk_bf16_f32 v67, v38, v39
    v_exp_f32 v42, v42
    v_exp_f32 v43, v43
    v_cvt_pk_bf16_f32 v68, v40, v41
    v_exp_f32 v44, v44
    v_exp_f32 v45, v45
    v_cvt_pk_bf16_f32 v69, v42, v43
    v_exp_f32 v46, v46
    v_exp_f32 v47, v47
    v_cvt_pk_bf16_f32 v70, v44, v45
    v_cvt_pk_bf16_f32 v71, v46, v47
    s_setprio 0
    s_waitcnt lgkmcnt(0)
    v_mfma_f32_32x32x16_bf16 v[32:47], v[92:95], v[4:7], v[16:31]
    v_mfma_f32_32x32x16_bf16 v[72:87], v[108:111], v[64:67], v[72:87]
    v_mfma_f32_32x32x16_bf16 v[72:87], v[112:115], v[68:71], v[72:87]
    ds_read_b128 v[100:103], v128 offset:28672
    ds_read_b128 v[104:107], v128 offset:29696
    v_mfma_f32_32x32x16_bf16 v[32:47], v[96:99], v[8:11], v[32:47]
    ds_read_b128 v[108:111], v128 offset:26624
    ds_read_b128 v[112:115], v128 offset:27648
    v_smfmac_f32_16x16x64_bf16 v[88:91], v[124:127], v[64:71], v15
    s_cbranch_vccnz SKB_mid_5
    s_waitcnt vmcnt(4)
    s_barrier
SKB_mid_5:
    v_exp_f32 v48, v48
    v_exp_f32 v49, v49
    v_exp_f32 v50, v50
    v_exp_f32 v51, v51
    v_cvt_pk_bf16_f32 v64, v48, v49
    s_setprio 2
    v_exp_f32 v52, v52
    v_exp_f32 v53, v53
    v_cvt_pk_bf16_f32 v65, v50, v51
    v_exp_f32 v54, v54
    v_exp_f32 v55, v55
    v_cvt_pk_bf16_f32 v66, v52, v53
    v_exp_f32 v56, v56
    v_exp_f32 v57, v57
    v_cvt_pk_bf16_f32 v67, v54, v55
    v_exp_f32 v58, v58
    v_exp_f32 v59, v59
    v_cvt_pk_bf16_f32 v68, v56, v57
    v_exp_f32 v60, v60
    v_exp_f32 v61, v61
    v_cvt_pk_bf16_f32 v69, v58, v59
    v_exp_f32 v62, v62
    v_exp_f32 v63, v63
    v_cvt_pk_bf16_f32 v70, v60, v61
    v_cvt_pk_bf16_f32 v71, v62, v63
    s_cbranch_vccz SKA_mid_5
    s_waitcnt vmcnt(4)
    s_barrier
SKA_mid_5:
    s_setprio 0
    s_waitcnt lgkmcnt(0)
    v_mfma_f32_32x32x16_bf16 v[48:63], v[100:103], v[4:7], v[16:31]
    s_add_u32 m0, s13, 0
    s_nop 0
    buffer_load_dwordx4 v1, s[8:11], s12 offen sc1 lds
    v_mfma_f32_32x32x16_bf16 v[72:87], v[116:119], v[64:67], v[72:87]
    v_mfma_f32_32x32x16_bf16 v[72:87], v[120:123], v[68:71], v[72:87]
    ds_read_b128 v[92:95], v128 offset:32768
    ds_read_b128 v[96:99], v128 offset:33792
    v_mfma_f32_32x32x16_bf16 v[48:63], v[104:107], v[8:11], v[48:63]
    ds_read_b128 v[116:119], v128 offset:30720
    ds_read_b128 v[120:123], v128 offset:31744
    v_smfmac_f32_16x16x64_bf16 v[88:91], v[124:127], v[64:71], v15
    v_exp_f32 v32, v32
    v_exp_f32 v33, v33
    v_exp_f32 v34, v34
    v_exp_f32 v35, v35
    v_cvt_pk_bf16_f32 v64, v32, v33
    s_setprio 2
    v_exp_f32 v36, v36
    v_exp_f32 v37, v37
    v_cvt_pk_bf16_f32 v65, v34, v35
    v_exp_f32 v38, v38
    v_exp_f32 v39, v39
    v_cvt_pk_bf16_f32 v66, v36, v37
    v_exp_f32 v40, v40
    v_exp_f32 v41, v41
    v_cvt_pk_bf16_f32 v67, v38, v39
    v_exp_f32 v42, v42
    v_exp_f32 v43, v43
    v_cvt_pk_bf16_f32 v68, v40, v41
    v_exp_f32 v44, v44
    v_exp_f32 v45, v45
    v_cvt_pk_bf16_f32 v69, v42, v43
    v_exp_f32 v46, v46
    v_exp_f32 v47, v47
    v_cvt_pk_bf16_f32 v70, v44, v45
    v_cvt_pk_bf16_f32 v71, v46, v47
    s_setprio 0
    s_waitcnt lgkmcnt(0)
    v_mfma_f32_32x32x16_bf16 v[32:47], v[92:95], v[4:7], v[16:31]
    buffer_load_dwordx4 v1, s[8:11], s12 offen offset:1024 sc1 lds
    s_add_u32 s12, s12, 16384
    v_mfma_f32_32x32x16_bf16 v[72:87], v[108:111], v[64:67], v[72:87]
    v_mfma_f32_32x32x16_bf16 v[72:87], v[112:115], v[68:71], v[72:87]
    ds_read_b128 v[100:103], v128 offset:36864
    ds_read_b128 v[104:107], v128 offset:37888
    v_mfma_f32_32x32x16_bf16 v[32:47], v[96:99], v[8:11], v[32:47]
    ds_read_b128 v[108:111], v128 offset:34816
    ds_read_b128 v[112:115], v128 offset:35840
    v_smfmac_f32_16x16x64_bf16 v[88:91], v[124:127], v[64:71], v15
    v_exp_f32 v48, v48
    v_exp_f32 v49, v49
    v_exp_f32 v50, v50
    v_exp_f32 v51, v51
    v_cvt_pk_bf16_f32 v64, v48, v49
    s_setprio 2
    v_exp_f32 v52, v52
    v_exp_f32 v53, v53
    v_cvt_pk_bf16_f32 v65, v50, v51
    v_exp_f32 v54, v54
    v_exp_f32 v55, v55
    v_cvt_pk_bf16_f32 v66, v52, v53
    v_exp_f32 v56, v56
    v_exp_f32 v57, v57
    v_cvt_pk_bf16_f32 v67, v54, v55
    v_exp_f32 v58, v58
    v_exp_f32 v59, v59
    v_cvt_pk_bf16_f32 v68, v56, v57
    v_exp_f32 v60, v60
    v_exp_f32 v61, v61
    v_cvt_pk_bf16_f32 v69, v58, v59
    v_exp_f32 v62, v62
    v_exp_f32 v63, v63
    v_cvt_pk_bf16_f32 v70, v60, v61
    v_cvt_pk_bf16_f32 v71, v62, v63
    s_setprio 0
    s_waitcnt lgkmcnt(0)
    v_mfma_f32_32x32x16_bf16 v[48:63], v[100:103], v[4:7], v[16:31]
    s_mov_b32 m0, s49
    s_add_u32 s49, s49, 8192
    buffer_load_dwordx4 v129, s[44:47], s48 offen lds
    s_add_u32 s48, s48, 131072
    v_mfma_f32_32x32x16_bf16 v[72:87], v[116:119], v[64:67], v[72:87]
    v_mfma_f32_32x32x16_bf16 v[72:87], v[120:123], v[68:71], v[72:87]
    ds_read_b128 v[92:95], v128 offset:40960
    ds_read_b128 v[96:99], v128 offset:41984
    v_mfma_f32_32x32x16_bf16 v[48:63], v[104:107], v[8:11], v[48:63]
    ds_read_b128 v[116:119], v128 offset:38912
    ds_read_b128 v[120:123], v128 offset:39936
    v_smfmac_f32_16x16x64_bf16 v[88:91], v[124:127], v[64:71], v15
    v_exp_f32 v32, v32
    v_exp_f32 v33, v33
    v_exp_f32 v34, v34
    v_exp_f32 v35, v35
    v_cvt_pk_bf16_f32 v64, v32, v33
    s_setprio 2
    v_exp_f32 v36, v36
    v_exp_f32 v37, v37
    v_cvt_pk_bf16_f32 v65, v34, v35
    v_exp_f32 v38, v38
    v_exp_f32 v39, v39
    v_cvt_pk_bf16_f32 v66, v36, v37
    v_exp_f32 v40, v40
    v_exp_f32 v41, v41
    v_cvt_pk_bf16_f32 v67, v38, v39
    v_exp_f32 v42, v42
    v_exp_f32 v43, v43
    v_cvt_pk_bf16_f32 v68, v40, v41
    v_exp_f32 v44, v44
    v_exp_f32 v45, v45
    v_cvt_pk_bf16_f32 v69, v42, v43
    v_exp_f32 v46, v46
    v_exp_f32 v47, v47
    v_cvt_pk_bf16_f32 v70, v44, v45
    v_cvt_pk_bf16_f32 v71, v46, v47
    s_setprio 0
    s_waitcnt lgkmcnt(0)
    v_mfma_f32_32x32x16_bf16 v[32:47], v[92:95], v[4:7], v[16:31]
    v_mfma_f32_32x32x16_bf16 v[72:87], v[108:111], v[64:67], v[72:87]
    v_mfma_f32_32x32x16_bf16 v[72:87], v[112:115], v[68:71], v[72:87]
    ds_read_b128 v[100:103], v128 offset:45056
    ds_read_b128 v[104:107], v128 offset:46080
    v_mfma_f32_32x32x16_bf16 v[32:47], v[96:99], v[8:11], v[32:47]
    ds_read_b128 v[108:111], v128 offset:43008
    ds_read_b128 v[112:115], v128 offset:44032
    v_smfmac_f32_16x16x64_bf16 v[88:91], v[124:127], v[64:71], v15
    s_cbranch_vccnz SKB_mid_9
    s_waitcnt vmcnt(4)
    s_barrier
SKB_mid_9:
    v_exp_f32 v48, v48
    v_exp_f32 v49, v49
    v_exp_f32 v50, v50
    v_exp_f32 v51, v51
    v_cvt_pk_bf16_f32 v64, v48, v49
    s_setprio 2
    v_exp_f32 v52, v52
    v_exp_f32 v53, v53
    v_cvt_pk_bf16_f32 v65, v50, v51
    v_exp_f32 v54, v54
    v_exp_f32 v55, v55
    v_cvt_pk_bf16_f32 v66, v52, v53
    v_exp_f32 v56, v56
    v_exp_f32 v57, v57
    v_cvt_pk_bf16_f32 v67, v54, v55
    v_exp_f32 v58, v58
    v_exp_f32 v59, v59
    v_cvt_pk_bf16_f32 v68, v56, v57
    v_exp_f32 v60, v60
    v_exp_f32 v61, v61
    v_cvt_pk_bf16_f32 v69, v58, v59
    v_exp_f32 v62, v62
    v_exp_f32 v63, v63
    v_cvt_pk_bf16_f32 v70, v60, v61
    v_cvt_pk_bf16_f32 v71, v62, v63
    s_cbranch_vccz SKA_mid_9
    s_waitcnt vmcnt(4)
    s_barrier
SKA_mid_9:
    s_setprio 0
    s_waitcnt lgkmcnt(0)
    v_mfma_f32_32x32x16_bf16 v[48:63], v[100:103], v[4:7], v[16:31]
    s_add_u32 m0, s13, 16384
    s_nop 0
    buffer_load_dwordx4 v1, s[8:11], s12 offen sc1 lds
    v_mfma_f32_32x32x16_bf16 v[72:87], v[116:119], v[64:67], v[72:87]
    v_mfma_f32_32x32x16_bf16 v[72:87], v[120:123], v[68:71], v[72:87]
    ds_read_b128 v[92:95], v128 offset:49152
    ds_read_b128 v[96:99], v128 offset:50176
    v_mfma_f32_32x32x16_bf16 v[48:63], v[104:107], v[8:11], v[48:63]
    ds_read_b128 v[116:119], v128 offset:47104
    ds_read_b128 v[120:123], v128 offset:48128
    v_smfmac_f32_16x16x64_bf16 v[88:91], v[124:127], v[64:71], v15
    v_exp_f32 v32, v32
    v_exp_f32 v33, v33
    v_exp_f32 v34, v34
    v_exp_f32 v35, v35
    v_cvt_pk_bf16_f32 v64, v32, v33
    s_setprio 2
    v_exp_f32 v36, v36
    v_exp_f32 v37, v37
    v_cvt_pk_bf16_f32 v65, v34, v35
    v_exp_f32 v38, v38
    v_exp_f32 v39, v39
    v_cvt_pk_bf16_f32 v66, v36, v37
    v_exp_f32 v40, v40
    v_exp_f32 v41, v41
    v_cvt_pk_bf16_f32 v67, v38, v39
    v_exp_f32 v42, v42
    v_exp_f32 v43, v43
    v_cvt_pk_bf16_f32 v68, v40, v41
    v_exp_f32 v44, v44
    v_exp_f32 v45, v45
    v_cvt_pk_bf16_f32 v69, v42, v43
    v_exp_f32 v46, v46
    v_exp_f32 v47, v47
    v_cvt_pk_bf16_f32 v70, v44, v45
    v_cvt_pk_bf16_f32 v71, v46, v47
    s_setprio 0
    s_waitcnt lgkmcnt(0)
    v_mfma_f32_32x32x16_bf16 v[32:47], v[92:95], v[4:7], v[16:31]
    buffer_load_dwordx4 v1, s[8:11], s12 offen offset:1024 sc1 lds
    s_add_u32 s12, s12, 16384
    v_mfma_f32_32x32x16_bf16 v[72:87], v[108:111], v[64:67], v[72:87]
    v_mfma_f32_32x32x16_bf16 v[72:87], v[112:115], v[68:71], v[72:87]
    ds_read_b128 v[100:103], v128 offset:53248
    ds_read_b128 v[104:107], v128 offset:54272
    v_mfma_f32_32x32x16_bf16 v[32:47], v[96:99], v[8:11], v[32:47]
    ds_read_b128 v[108:111], v128 offset:51200
    ds_read_b128 v[112:115], v128 offset:52224
    v_smfmac_f32_16x16x64_bf16 v[88:91], v[124:127], v[64:71], v15
    v_exp_f32 v48, v48
    v_exp_f32 v49, v49
    v_exp_f32 v50, v50
    v_exp_f32 v51, v51
    v_cvt_pk_bf16_f32 v64, v48, v49
    s_setprio 2
    v_exp_f32 v52, v52
    v_exp_f32 v53, v53
    v_cvt_pk_bf16_f32 v65, v50, v51
    v_exp_f32 v54, v54
    v_exp_f32 v55, v55
    v_cvt_pk_bf16_f32 v66, v52, v53
    v_exp_f32 v56, v56
    v_exp_f32 v57, v57
    v_cvt_pk_bf16_f32 v67, v54, v55
    v_exp_f32 v58, v58
    v_exp_f32 v59, v59
    v_cvt_pk_bf16_f32 v68, v56, v57
    v_exp_f32 v60, v60
    v_exp_f32 v61, v61
    v_cvt_pk_bf16_f32 v69, v58, v59
    v_exp_f32 v62, v62
    v_exp_f32 v63, v63
    v_cvt_pk_bf16_f32 v70, v60, v61
    v_cvt_pk_bf16_f32 v71, v62, v63
    s_setprio 0
    s_waitcnt lgkmcnt(0)
    v_mfma_f32_32x32x16_bf16 v[48:63], v[100:103], v[4:7], v[16:31]
    s_mov_b32 m0, s49
    s_add_u32 s49, s49, 8192
    buffer_load_dwordx4 v129, s[44:47], s48 offen lds
    s_add_u32 s48, s48, 131072
    v_mfma_f32_32x32x16_bf16 v[72:87], v[116:119], v[64:67], v[72:87]
    v_mfma_f32_32x32x16_bf16 v[72:87], v[120:123], v[68:71], v[72:87]
    ds_read_b128 v[92:95], v128 offset:57344
    ds_read_b128 v[96:99], v128 offset:58368
    v_mfma_f32_32x32x16_bf16 v[48:63], v[104:107], v[8:11], v[48:63]
    ds_read_b128 v[116:119], v128 offset:55296
    ds_read_b128 v[120:123], v128 offset:56320
    v_smfmac_f32_16x16x64_bf16 v[88:91], v[124:127], v[64:71], v15
    v_exp_f32 v32, v32
    v_exp_f32 v33, v33
    v_exp_f32 v34, v34
    v_exp_f32 v35, v35
    v_cvt_pk_bf16_f32 v64, v32, v33
    s_setprio 2
    v_exp_f32 v36, v36
    v_exp_f32 v37, v37
    v_cvt_pk_bf16_f32 v65, v34, v35
    v_exp_f32 v38, v38
    v_exp_f32 v39, v39
    v_cvt_pk_bf16_f32 v66, v36, v37
    v_exp_f32 v40, v40
    v_exp_f32 v41, v41
    v_cvt_pk_bf16_f32 v67, v38, v39
    v_exp_f32 v42, v42
    v_exp_f32 v43, v43
    v_cvt_pk_bf16_f32 v68, v40, v41
    v_exp_f32 v44, v44
    v_exp_f32 v45, v45
    v_cvt_pk_bf16_f32 v69, v42, v43
    v_exp_f32 v46, v46
    v_exp_f32 v47, v47
    v_cvt_pk_bf16_f32 v70, v44, v45
    v_cvt_pk_bf16_f32 v71, v46, v47
    s_setprio 0
    s_waitcnt lgkmcnt(0)
    v_mfma_f32_32x32x16_bf16 v[32:47], v[92:95], v[4:7], v[16:31]
    v_mfma_f32_32x32x16_bf16 v[72:87], v[108:111], v[64:67], v[72:87]
    v_mfma_f32_32x32x16_bf16 v[72:87], v[112:115], v[68:71], v[72:87]
    ds_read_b128 v[100:103], v128 offset:61440
    ds_read_b128 v[104:107], v128 offset:62464
    v_mfma_f32_32x32x16_bf16 v[32:47], v[96:99], v[8:11], v[32:47]
    ds_read_b128 v[108:111], v128 offset:59392
    ds_read_b128 v[112:115], v128 offset:60416
    v_smfmac_f32_16x16x64_bf16 v[88:91], v[124:127], v[64:71], v15
    s_cbranch_vccnz SKB_mid_13
    s_waitcnt vmcnt(4)
    s_barrier
SKB_mid_13:
    v_exp_f32 v48, v48
    v_exp_f32 v49, v49
    v_exp_f32 v50, v50
    v_exp_f32 v51, v51
    v_cvt_pk_bf16_f32 v64, v48, v49
    s_setprio 2
    v_exp_f32 v52, v52
    v_exp_f32 v53, v53
    v_cvt_pk_bf16_f32 v65, v50, v51
    v_exp_f32 v54, v54
    v_exp_f32 v55, v55
    v_cvt_pk_bf16_f32 v66, v52, v53
    v_exp_f32 v56, v56
    v_exp_f32 v57, v57
    v_cvt_pk_bf16_f32 v67, v54, v55
    v_exp_f32 v58, v58
    v_exp_f32 v59, v59
    v_cvt_pk_bf16_f32 v68, v56, v57
    v_exp_f32 v60, v60
    v_exp_f32 v61, v61
    v_cvt_pk_bf16_f32 v69, v58, v59
    v_exp_f32 v62, v62
    v_exp_f32 v63, v63
    v_cvt_pk_bf16_f32 v70, v60, v61
    v_cvt_pk_bf16_f32 v71, v62, v63
    s_cbranch_vccz SKA_mid_13
    s_waitcnt vmcnt(4)
    s_barrier
SKA_mid_13:
    s_setprio 0
    s_waitcnt lgkmcnt(0)
    v_mfma_f32_32x32x16_bf16 v[48:63], v[100:103], v[4:7], v[16:31]
    s_add_u32 m0, s13, 32768
    s_nop 0
    buffer_load_dwordx4 v1, s[8:11], s12 offen sc1 lds
    v_mfma_f32_32x32x16_bf16 v[72:87], v[116:119], v[64:67], v[72:87]
    v_mfma_f32_32x32x16_bf16 v[72:87], v[120:123], v[68:71], v[72:87]
    ds_read_b128 v[92:95], v128 offset:0
    ds_read_b128 v[96:99], v128 offset:1024
    v_mfma_f32_32x32x16_bf16 v[48:63], v[104:107], v[8:11], v[48:63]
    ds_read_b128 v[116:119], v128 offset:63488
    ds_read_b128 v[120:123], v128 offset:64512
    v_smfmac_f32_16x16x64_bf16 v[88:91], v[124:127], v[64:71], v15
    v_exp_f32 v32, v32
    v_exp_f32 v33, v33
    v_exp_f32 v34, v34
    v_exp_f32 v35, v35
    v_cvt_pk_bf16_f32 v64, v32, v33
    s_setprio 2
    v_exp_f32 v36, v36
    v_exp_f32 v37, v37
    v_cvt_pk_bf16_f32 v65, v34, v35
    v_exp_f32 v38, v38
    v_exp_f32 v39, v39
    v_cvt_pk_bf16_f32 v66, v36, v37
    v_exp_f32 v40, v40
    v_exp_f32 v41, v41
    v_cvt_pk_bf16_f32 v67, v38, v39
    v_exp_f32 v42, v42
    v_exp_f32 v43, v43
    v_cvt_pk_bf16_f32 v68, v40, v41
    v_exp_f32 v44, v44
    v_exp_f32 v45, v45
    v_cvt_pk_bf16_f32 v69, v42, v43
    v_exp_f32 v46, v46
    v_exp_f32 v47, v47
    v_cvt_pk_bf16_f32 v70, v44, v45
    v_cvt_pk_bf16_f32 v71, v46, v47
    s_setprio 0
    s_waitcnt lgkmcnt(0)
    v_mfma_f32_32x32x16_bf16 v[32:47], v[92:95], v[4:7], v[16:31]
    buffer_load_dwordx4 v1, s[8:11], s12 offen offset:1024 sc1 lds
    s_add_u32 s12, s12, 16384
    v_mfma_f32_32x32x16_bf16 v[72:87], v[108:111], v[64:67], v[72:87]
    v_mfma_f32_32x32x16_bf16 v[72:87], v[112:115], v[68:71], v[72:87]
    ds_read_b128 v[100:103], v128 offset:4096
    ds_read_b128 v[104:107], v128 offset:5120
    v_mfma_f32_32x32x16_bf16 v[32:47], v[96:99], v[8:11], v[32:47]
    ds_read_b128 v[108:111], v128 offset:2048
    ds_read_b128 v[112:115], v128 offset:3072
    v_smfmac_f32_16x16x64_bf16 v[88:91], v[124:127], v[64:71], v15
    v_exp_f32 v48, v48
    v_exp_f32 v49, v49
    v_exp_f32 v50, v50
    v_exp_f32 v51, v51
    v_cvt_pk_bf16_f32 v64, v48, v49
    s_setprio 2
    v_exp_f32 v52, v52
    v_exp_f32 v53, v53
    v_cvt_pk_bf16_f32 v65, v50, v51
    v_exp_f32 v54, v54
    v_exp_f32 v55, v55
    v_cvt_pk_bf16_f32 v66, v52, v53
    v_exp_f32 v56, v56
    v_exp_f32 v57, v57
    v_cvt_pk_bf16_f32 v67, v54, v55
    v_exp_f32 v58, v58
    v_exp_f32 v59, v59
    v_cvt_pk_bf16_f32 v68, v56, v57
    v_exp_f32 v60, v60
    v_exp_f32 v61, v61
    v_cvt_pk_bf16_f32 v69, v58, v59
    v_exp_f32 v62, v62
    v_exp_f32 v63, v63
    v_cvt_pk_bf16_f32 v70, v60, v61
    v_cvt_pk_bf16_f32 v71, v62, v63
    s_add_u32 s14, s14, 1
    s_cmp_lt_u32 s14, 2
    s_cbranch_scc1 P2_LOOP
    s_setprio 0
    s_waitcnt lgkmcnt(0)
    v_mfma_f32_32x32x16_bf16 v[48:63], v[100:103], v[4:7], v[16:31]
    s_mov_b32 m0, s49
    s_add_u32 s49, s49, 8192
    buffer_load_dwordx4 v129, s[44:47], s48 offen lds
    s_add_u32 s48, s48, 131072
    v_mfma_f32_32x32x16_bf16 v[72:87], v[116:119], v[64:67], v[72:87]
    v_mfma_f32_32x32x16_bf16 v[72:87], v[120:123], v[68:71], v[72:87]
    ds_read_b128 v[92:95], v128 offset:8192
    ds_read_b128 v[96:99], v128 offset:9216
    v_mfma_f32_32x32x16_bf16 v[48:63], v[104:107], v[8:11], v[48:63]
    ds_read_b128 v[116:119], v128 offset:6144
    ds_read_b128 v[120:123], v128 offset:7168
    v_smfmac_f32_16x16x64_bf16 v[88:91], v[124:127], v[64:71], v15
    buffer_load_dwordx4 v[144:147], v134, s[52:55], 0 offen offset:0 nt
    v_exp_f32 v32, v32
    v_exp_f32 v33, v33
    v_exp_f32 v34, v34
    v_exp_f32 v35, v35
    v_cvt_pk_bf16_f32 v64, v32, v33
    s_setprio 2
    v_exp_f32 v36, v36
    v_exp_f32 v37, v37
    v_cvt_pk_bf16_f32 v65, v34, v35
    v_exp_f32 v38, v38
    v_exp_f32 v39, v39
    v_cvt_pk_bf16_f32 v66, v36, v37
    v_exp_f32 v40, v40
    v_exp_f32 v41, v41
    v_cvt_pk_bf16_f32 v67, v38, v39
    v_exp_f32 v42, v42
    v_exp_f32 v43, v43
    v_cvt_pk_bf16_f32 v68, v40, v41
    v_exp_f32 v44, v44
    v_exp_f32 v45, v45
    v_cvt_pk_bf16_f32 v69, v42, v43
    v_exp_f32 v46, v46
    v_exp_f32 v47, v47
    v_cvt_pk_bf16_f32 v70, v44, v45
    v_cvt_pk_bf16_f32 v71, v46, v47
    s_setprio 0
    s_waitcnt lgkmcnt(0)
    v_mfma_f32_32x32x16_bf16 v[32:47], v[92:95], v[4:7], v[16:31]
    buffer_load_dword v135, v254, s[8:11], s56 offen sc1
    v_mfma_f32_32x32x16_bf16 v[72:87], v[108:111], v[64:67], v[72:87]
    v_mfma_f32_32x32x16_bf16 v[72:87], v[112:115], v[68:71], v[72:87]
    ds_read_b128 v[100:103], v128 offset:12288
    ds_read_b128 v[104:107], v128 offset:13312
    v_mfma_f32_32x32x16_bf16 v[32:47], v[96:99], v[8:11], v[32:47]
    ds_read_b128 v[108:111], v128 offset:10240
    ds_read_b128 v[112:115], v128 offset:11264
    v_smfmac_f32_16x16x64_bf16 v[88:91], v[124:127], v[64:71], v15
    buffer_load_dwordx4 v[148:151], v134, s[52:55], 0 offen offset:2048 nt
    s_cbranch_vccnz SKB_last_1
    s_waitcnt vmcnt(7)
    s_barrier
SKB_last_1:
    v_exp_f32 v48, v48
    v_exp_f32 v49, v49
    v_exp_f32 v50, v50
    v_exp_f32 v51, v51
    v_cvt_pk_bf16_f32 v64, v48, v49
    s_setprio 2
    v_exp_f32 v52, v52
    v_exp_f32 v53, v53
    v_cvt_pk_bf16_f32 v65, v50, v51
    v_exp_f32 v54, v54
    v_exp_f32 v55, v55
    v_cvt_pk_bf16_f32 v66, v52, v53
    v_exp_f32 v56, v56
    v_exp_f32 v57, v57
    v_cvt_pk_bf16_f32 v67, v54, v55
    v_exp_f32 v58, v58
    v_exp_f32 v59, v59
    v_cvt_pk_bf16_f32 v68, v56, v57
    v_exp_f32 v60, v60
    v_exp_f32 v61, v61
    v_cvt_pk_bf16_f32 v69, v58, v59
    v_exp_f32 v62, v62
    v_exp_f32 v63, v63
    v_cvt_pk_bf16_f32 v70, v60, v61
    v_cvt_pk_bf16_f32 v71, v62, v63
    s_cbranch_vccz SKA_last_1
    s_waitcnt vmcnt(7)
    s_barrier
SKA_last_1:
    s_setprio 0
    s_waitcnt lgkmcnt(0)
    v_mfma_f32_32x32x16_bf16 v[48:63], v[100:103], v[4:7], v[16:31]
    s_add_u32 m0, s13, 49152
    s_nop 0
    buffer_load_dwordx4 v1, s[8:11], s12 offen sc1 lds
    v_mfma_f32_32x32x16_bf16 v[72:87], v[116:119], v[64:67], v[72:87]
    v_mfma_f32_32x32x16_bf16 v[72:87], v[120:123], v[68:71], v[72:87]
    ds_read_b128 v[92:95], v128 offset:16384
    ds_read_b128 v[96:99], v128 offset:17408
    v_mfma_f32_32x32x16_bf16 v[48:63], v[104:107], v[8:11], v[48:63]
    ds_read_b128 v[116:119], v128 offset:14336
    ds_read_b128 v[120:123], v128 offset:15360
    v_smfmac_f32_16x16x64_bf16 v[88:91], v[124:127], v[64:71], v15
    v_exp_f32 v32, v32
    v_exp_f32 v33, v33
    v_exp_f32 v34, v34
    v_exp_f32 v35, v35
    v_cvt_pk_bf16_f32 v64, v32, v33
    s_setprio 2
    v_exp_f32 v36, v36
    v_exp_f32 v37, v37
    v_cvt_pk_bf16_f32 v65, v34, v35
    v_exp_f32 v38, v38
    v_exp_f32 v39, v39
    v_cvt_pk_bf16_f32 v66, v36, v37
    v_exp_f32 v40, v40
    v_exp_f32 v41, v41
    v_cvt_pk_bf16_f32 v67, v38, v39
    v_exp_f32 v42, v42
    v_exp_f32 v43, v43
    v_cvt_pk_bf16_f32 v68, v40, v41
    v_exp_f32 v44, v44
    v_exp_f32 v45, v45
    v_cvt_pk_bf16_f32 v69, v42, v43
    v_exp_f32 v46, v46
    v_exp_f32 v47, v47
    v_cvt_pk_bf16_f32 v70, v44, v45
    v_cvt_pk_bf16_f32 v71, v46, v47
    s_setprio 0
    s_waitcnt lgkmcnt(0)
    v_mfma_f32_32x32x16_bf16 v[32:47], v[92:95], v[4:7], v[16:31]
    buffer_load_dwordx4 v1, s[8:11], s12 offen offset:1024 sc1 lds
    s_add_u32 s12, s12, 16384
    v_mfma_f32_32x32x16_bf16 v[72:87], v[108:111], v[64:67], v[72:87]
    v_mfma_f32_32x32x16_bf16 v[72:87], v[112:115], v[68:71], v[72:87]
    ds_read_b128 v[100:103], v128 offset:20480
    ds_read_b128 v[104:107], v128 offset:21504
    v_mfma_f32_32x32x16_bf16 v[32:47], v[96:99], v[8:11], v[32:47]
    ds_read_b128 v[108:111], v128 offset:18432
    ds_read_b128 v[112:115], v128 offset:19456
    v_smfmac_f32_16x16x64_bf16 v[88:91], v[124:127], v[64:71], v15
    v_exp_f32 v48, v48
    v_exp_f32 v49, v49
    v_exp_f32 v50, v50
    v_exp_f32 v51, v51
    v_cvt_pk_bf16_f32 v64, v48, v49
    s_setprio 2
    v_exp_f32 v52, v52
    v_exp_f32 v53, v53
    v_cvt_pk_bf16_f32 v65, v50, v51
    v_exp_f32 v54, v54
    v_exp_f32 v55, v55
    v_cvt_pk_bf16_f32 v66, v52, v53
    v_exp_f32 v56, v56
    v_exp_f32 v57, v57
    v_cvt_pk_bf16_f32 v67, v54, v55
    v_exp_f32 v58, v58
    v_exp_f32 v59, v59
    v_cvt_pk_bf16_f32 v68, v56, v57
    v_exp_f32 v60, v60
    v_exp_f32 v61, v61
    v_cvt_pk_bf16_f32 v69, v58, v59
    v_exp_f32 v62, v62
    v_exp_f32 v63, v63
    v_cvt_pk_bf16_f32 v70, v60, v61
    v_cvt_pk_bf16_f32 v71, v62, v63
    s_setprio 0
    s_waitcnt lgkmcnt(0)
    v_mfma_f32_32x32x16_bf16 v[48:63], v[100:103], v[4:7], v[16:31]
    s_waitcnt vmcnt(3)
    v_cmp_eq_u32 s[100:101], 1, v135
    s_cmp_eq_u64 s[100:101], -1
    s_cbranch_scc1 POLLZ_OK
    s_mov_b32 s98, 0
POLLZ:
    buffer_load_dword v135, v254, s[8:11], s56 offen sc1
    s_waitcnt vmcnt(0)
    v_cmp_eq_u32 s[100:101], 1, v135
    s_cmp_eq_u64 s[100:101], -1
    s_cbranch_scc1 POLLZ_OK
    s_sleep 2
    s_add_u32 s98, s98, 1
    s_cmp_lt_u32 s98, 0x80000
    s_cbranch_scc1 POLLZ
POLLZ_OK:
    buffer_load_dwordx4 v[152:155], v129, s[44:47], s48 offen
    s_add_u32 s48, s48, 131072
    v_mfma_f32_32x32x16_bf16 v[72:87], v[116:119], v[64:67], v[72:87]
    v_mfma_f32_32x32x16_bf16 v[72:87], v[120:123], v[68:71], v[72:87]
    ds_read_b128 v[92:95], v128 offset:24576
    ds_read_b128 v[96:99], v128 offset:25600
    v_mfma_f32_32x32x16_bf16 v[48:63], v[104:107], v[8:11], v[48:63]
    ds_read_b128 v[116:119], v128 offset:22528
    ds_read_b128 v[120:123], v128 offset:23552
    v_smfmac_f32_16x16x64_bf16 v[88:91], v[124:127], v[64:71], v15
    s_mov_b32 s51, 20971520
    buffer_load_dword v136, v132, s[8:11], s51 offen sc1
    v_exp_f32 v32, v32
    v_exp_f32 v33, v33
    v_exp_f32 v34, v34
    v_exp_f32 v35, v35
    v_cvt_pk_bf16_f32 v64, v32, v33
    s_setprio 2
    v_exp_f32 v36, v36
    v_exp_f32 v37, v37
    v_cvt_pk_bf16_f32 v65, v34, v35
    v_exp_f32 v38, v38
    v_exp_f32 v39, v39
    v_cvt_pk_bf16_f32 v66, v36, v37
    v_exp_f32 v40, v40
    v_exp_f32 v41, v41
    v_cvt_pk_bf16_f32 v67, v38, v39
    v_exp_f32 v42, v42
    v_exp_f32 v43, v43
    v_cvt_pk_bf16_f32 v68, v40, v41
    v_exp_f32 v44, v44
    v_exp_f32 v45, v45
    v_cvt_pk_bf16_f32 v69, v42, v43
    v_exp_f32 v46, v46
    v_exp_f32 v47, v47
    v_cvt_pk_bf16_f32 v70, v44, v45
    v_cvt_pk_bf16_f32 v71, v46, v47
    s_setprio 0
    s_waitcnt lgkmcnt(0)
    v_mfma_f32_32x32x16_bf16 v[32:47], v[92:95], v[4:7], v[16:31]
    buffer_load_dwordx4 v[156:159], v129, s[44:47], s48 offen
    s_add_u32 s48, s48, 131072
    v_mfma_f32_32x32x16_bf16 v[72:87], v[108:111], v[64:67], v[72:87]
    v_mfma_f32_32x32x16_bf16 v[72:87], v[112:115], v[68:71], v[72:87]
    ds_read_b128 v[100:103], v128 offset:28672
    ds_read_b128 v[104:107], v128 offset:29696
    v_mfma_f32_32x32x16_bf16 v[32:47], v[96:99], v[8:11], v[32:47]
    ds_read_b128 v[108:111], v128 offset:26624
    ds_read_b128 v[112:115], v128 offset:27648
    v_smfmac_f32_16x16x64_bf16 v[88:91], v[124:127], v[64:71], v15
    s_mov_b32 s51, 20975616
    buffer_load_dword v137, v132, s[8:11], s51 offen sc1
    s_cbranch_vccnz SKB_last_5
    s_nop 0
    s_barrier
SKB_last_5:
    v_exp_f32 v48, v48
    v_exp_f32 v49, v49
    v_exp_f32 v50, v50
    v_exp_f32 v51, v51
    v_cvt_pk_bf16_f32 v64, v48, v49
    s_setprio 2
    v_exp_f32 v52, v52
    v_exp_f32 v53, v53
    v_cvt_pk_bf16_f32 v65, v50, v51
    v_exp_f32 v54, v54
    v_exp_f32 v55, v55
    v_cvt_pk_bf16_f32 v66, v52, v53
    v_exp_f32 v56, v56
    v_exp_f32 v57, v57
    v_cvt_pk_bf16_f32 v67, v54, v55
    v_exp_f32 v58, v58
    v_exp_f32 v59, v59
    v_cvt_pk_bf16_f32 v68, v56, v57
    v_exp_f32 v60, v60
    v_exp_f32 v61, v61
    v_cvt_pk_bf16_f32 v69, v58, v59
    v_exp_f32 v62, v62
    v_exp_f32 v63, v63
    v_cvt_pk_bf16_f32 v70, v60, v61
    v_cvt_pk_bf16_f32 v71, v62, v63
    s_cbranch_vccz SKA_last_5
    s_nop 0
    s_barrier
SKA_last_5:
    s_setprio 0
    s_waitcnt lgkmcnt(0)
    v_mfma_f32_32x32x16_bf16 v[48:63], v[100:103], v[4:7], v[16:31]
    buffer_load_dwordx4 v[160:163], v129, s[44:47], s48 offen
    s_add_u32 s48, s48, 131072
    v_mfma_f32_32x32x16_bf16 v[72:87], v[116:119], v[64:67], v[72:87]
    v_mfma_f32_32x32x16_bf16 v[72:87], v[120:123], v[68:71], v[72:87]
    ds_read_b128 v[92:95], v128 offset:32768
    ds_read_b128 v[96:99], v128 offset:33792
    v_mfma_f32_32x32x16_bf16 v[48:63], v[104:107], v[8:11], v[48:63]
    ds_read_b128 v[116:119], v128 offset:30720
    ds_read_b128 v[120:123], v128 offset:31744
    v_smfmac_f32_16x16x64_bf16 v[88:91], v[124:127], v[64:71], v15
    s_mov_b32 s51, 20979712
    buffer_load_dword v138, v132, s[8:11], s51 offen sc1
    v_exp_f32 v32, v32
    v_exp_f32 v33, v33
    v_exp_f32 v34, v34
    v_exp_f32 v35, v35
    v_cvt_pk_bf16_f32 v64, v32, v33
    s_setprio 2
    v_exp_f32 v36, v36
    v_exp_f32 v37, v37
    v_cvt_pk_bf16_f32 v65, v34, v35
    v_exp_f32 v38, v38
    v_exp_f32 v39, v39
    v_cvt_pk_bf16_f32 v66, v36, v37
    v_exp_f32 v40, v40
    v_exp_f32 v41, v41
    v_cvt_pk_bf16_f32 v67, v38, v39
    v_exp_f32 v42, v42
    v_exp_f32 v43, v43
    v_cvt_pk_bf16_f32 v68, v40, v41
    v_exp_f32 v44, v44
    v_exp_f32 v45, v45
    v_cvt_pk_bf16_f32 v69, v42, v43
    v_exp_f32 v46, v46
    v_exp_f32 v47, v47
    v_cvt_pk_bf16_f32 v70, v44, v45
    v_cvt_pk_bf16_f32 v71, v46, v47
    s_setprio 0
    s_waitcnt lgkmcnt(0)
    v_mfma_f32_32x32x16_bf16 v[32:47], v[92:95], v[4:7], v[16:31]
    buffer_load_dwordx4 v[164:167], v129, s[44:47], s48 offen
    s_add_u32 s48, s48, 131072
    v_mfma_f32_32x32x16_bf16 v[72:87], v[108:111], v[64:67], v[72:87]
    v_mfma_f32_32x32x16_bf16 v[72:87], v[112:115], v[68:71], v[72:87]
    ds_read_b128 v[100:103], v128 offset:36864
    ds_read_b128 v[104:107], v128 offset:37888
    v_mfma_f32_32x32x16_bf16 v[32:47], v[96:99], v[8:11], v[32:47]
    ds_read_b128 v[108:111], v128 offset:34816
    ds_read_b128 v[112:115], v128 offset:35840
    v_smfmac_f32_16x16x64_bf16 v[88:91], v[124:127], v[64:71], v15
    s_mov_b32 s51, 20983808
    buffer_load_dword v139, v132, s[8:11], s51 offen sc1
    v_exp_f32 v48, v48
    v_exp_f32 v49, v49
    v_exp_f32 v50, v50
    v_exp_f32 v51, v51
    v_cvt_pk_bf16_f32 v64, v48, v49
    s_setprio 2
    v_exp_f32 v52, v52
    v_exp_f32 v53, v53
    v_cvt_pk_bf16_f32 v65, v50, v51
    v_exp_f32 v54, v54
    v_exp_f32 v55, v55
    v_cvt_pk_bf16_f32 v66, v52, v53
    v_exp_f32 v56, v56
    v_exp_f32 v57, v57
    v_cvt_pk_bf16_f32 v67, v54, v55
    v_exp_f32 v58, v58
    v_exp_f32 v59, v59
    v_cvt_pk_bf16_f32 v68, v56, v57
    v_exp_f32 v60, v60
    v_exp_f32 v61, v61
    v_cvt_pk_bf16_f32 v69, v58, v59
    v_exp_f32 v62, v62
    v_exp_f32 v63, v63
    v_cvt_pk_bf16_f32 v70, v60, v61
    v_cvt_pk_bf16_f32 v71, v62, v63
    s_setprio 0
    s_waitcnt lgkmcnt(0)
    v_mfma_f32_32x32x16_bf16 v[48:63], v[100:103], v[4:7], v[16:31]
    s_mov_b32 s51, 20987904
    buffer_load_dword v140, v132, s[8:11], s51 offen sc1
    v_mfma_f32_32x32x16_bf16 v[72:87], v[116:119], v[64:67], v[72:87]
    v_mfma_f32_32x32x16_bf16 v[72:87], v[120:123], v[68:71], v[72:87]
    ds_read_b128 v[92:95], v128 offset:40960
    ds_read_b128 v[96:99], v128 offset:41984
    v_mfma_f32_32x32x16_bf16 v[48:63], v[104:107], v[8:11], v[48:63]
    ds_read_b128 v[116:119], v128 offset:38912
    ds_read_b128 v[120:123], v128 offset:39936
    v_smfmac_f32_16x16x64_bf16 v[88:91], v[124:127], v[64:71], v15
    s_mov_b32 s51, 20992000
    buffer_load_dword v141, v132, s[8:11], s51 offen sc1
    v_exp_f32 v32, v32
    v_exp_f32 v33, v33
    v_exp_f32 v34, v34
    v_exp_f32 v35, v35
    v_cvt_pk_bf16_f32 v64, v32, v33
    s_setprio 2
    v_exp_f32 v36, v36
    v_exp_f32 v37, v37
    v_cvt_pk_bf16_f32 v65, v34, v35
    v_exp_f32 v38, v38
    v_exp_f32 v39, v39
    v_cvt_pk_bf16_f32 v66, v36, v37
    v_exp_f32 v40, v40
    v_exp_f32 v41, v41
    v_cvt_pk_bf16_f32 v67, v38, v39
    v_exp_f32 v42, v42
    v_exp_f32 v43, v43
    v_cvt_pk_bf16_f32 v68, v40, v41
    v_exp_f32 v44, v44
    v_exp_f32 v45, v45
    v_cvt_pk_bf16_f32 v69, v42, v43
    v_exp_f32 v46, v46
    v_exp_f32 v47, v47
    v_cvt_pk_bf16_f32 v70, v44, v45
    v_cvt_pk_bf16_f32 v71, v46, v47
    s_setprio 0
    s_waitcnt lgkmcnt(0)
    v_mfma_f32_32x32x16_bf16 v[32:47], v[92:95], v[4:7], v[16:31]
    s_mov_b32 s51, 20996096
    buffer_load_dword v142, v132, s[8:11], s51 offen sc1
    v_mfma_f32_32x32x16_bf16 v[72:87], v[108:111], v[64:67], v[72:87]
    v_mfma_f32_32x32x16_bf16 v[72:87], v[112:115], v[68:71], v[72:87]
    ds_read_b128 v[100:103], v128 offset:45056
    ds_read_b128 v[104:107], v128 offset:46080
    v_mfma_f32_32x32x16_bf16 v[32:47], v[96:99], v[8:11], v[32:47]
    ds_read_b128 v[108:111], v128 offset:43008
    ds_read_b128 v[112:115], v128 offset:44032
    v_smfmac_f32_16x16x64_bf16 v[88:91], v[124:127], v[64:71], v15
    s_mov_b32 s51, 21000192
    buffer_load_dword v143, v132, s[8:11], s51 offen sc1
    s_cbranch_vccnz SKB_last_9
    s_waitcnt vmcnt(12)
    s_barrier
SKB_last_9:
    v_exp_f32 v48, v48
    v_exp_f32 v49, v49
    v_exp_f32 v50, v50
    v_exp_f32 v51, v51
    v_cvt_pk_bf16_f32 v64, v48, v49
    s_setprio 2
    v_exp_f32 v52, v52
    v_exp_f32 v53, v53
    v_cvt_pk_bf16_f32 v65, v50, v51
    v_exp_f32 v54, v54
    v_exp_f32 v55, v55
    v_cvt_pk_bf16_f32 v66, v52, v53
    v_exp_f32 v56, v56
    v_exp_f32 v57, v57
    v_cvt_pk_bf16_f32 v67, v54, v55
    v_exp_f32 v58, v58
    v_exp_f32 v59, v59
    v_cvt_pk_bf16_f32 v68, v56, v57
    v_exp_f32 v60, v60
    v_exp_f32 v61, v61
    v_cvt_pk_bf16_f32 v69, v58, v59
    v_exp_f32 v62, v62
    v_exp_f32 v63, v63
    v_cvt_pk_bf16_f32 v70, v60, v61
    v_cvt_pk_bf16_f32 v71, v62, v63
    s_cbranch_vccz SKA_last_9
    s_waitcnt vmcnt(12)
    s_barrier
SKA_last_9:
    s_setprio 0
    s_waitcnt lgkmcnt(0)
    v_mfma_f32_32x32x16_bf16 v[48:63], v[100:103], v[4:7], v[16:31]
    buffer_load_dword v135, v131, s[8:11], s59 offen sc1
    v_mfma_f32_32x32x16_bf16 v[72:87], v[116:119], v[64:67], v[72:87]
    v_mfma_f32_32x32x16_bf16 v[72:87], v[120:123], v[68:71], v[72:87]
    ds_read_b128 v[92:95], v128 offset:49152
    ds_read_b128 v[96:99], v128 offset:50176
    v_mfma_f32_32x32x16_bf16 v[48:63], v[104:107], v[8:11], v[48:63]
    ds_read_b128 v[116:119], v128 offset:47104
    ds_read_b128 v[120:123], v128 offset:48128
    v_smfmac_f32_16x16x64_bf16 v[88:91], v[124:127], v[64:71], v15
    v_exp_f32 v32, v32
    v_exp_f32 v33, v33
    v_exp_f32 v34, v34
    v_exp_f32 v35, v35
    v_cvt_pk_bf16_f32 v64, v32, v33
    s_setprio 2
    v_exp_f32 v36, v36
    v_exp_f32 v37, v37
    v_cvt_pk_bf16_f32 v65, v34, v35
    v_exp_f32 v38, v38
    v_exp_f32 v39, v39
    v_cvt_pk_bf16_f32 v66, v36, v37
    v_exp_f32 v40, v40
    v_exp_f32 v41, v41
    v_cvt_pk_bf16_f32 v67, v38, v39
    v_exp_f32 v42, v42
    v_exp_f32 v43, v43
    v_cvt_pk_bf16_f32 v68, v40, v41
    v_exp_f32 v44, v44
    v_exp_f32 v45, v45
    v_cvt_pk_bf16_f32 v69, v42, v43
    v_exp_f32 v46, v46
    v_exp_f32 v47, v47
    v_cvt_pk_bf16_f32 v70, v44, v45
    v_cvt_pk_bf16_f32 v71, v46, v47
    s_setprio 0
    s_waitcnt lgkmcnt(0)
    v_mfma_f32_32x32x16_bf16 v[32:47], v[92:95], v[4:7], v[16:31]
    v_mfma_f32_32x32x16_bf16 v[72:87], v[108:111], v[64:67], v[72:87]
    v_mfma_f32_32x32x16_bf16 v[72:87], v[112:115], v[68:71], v[72:87]
    ds_read_b128 v[100:103], v128 offset:53248
    ds_read_b128 v[104:107], v128 offset:54272
    v_mfma_f32_32x32x16_bf16 v[32:47], v[96:99], v[8:11], v[32:47]
    ds_read_b128 v[108:111], v128 offset:51200
    ds_read_b128 v[112:115], v128 offset:52224
    v_smfmac_f32_16x16x64_bf16 v[88:91], v[124:127], v[64:71], v15
    v_exp_f32 v48, v48
    v_exp_f32 v49, v49
    v_exp_f32 v50, v50
    v_exp_f32 v51, v51
    v_cvt_pk_bf16_f32 v64, v48, v49
    s_setprio 2
    v_exp_f32 v52, v52
    v_exp_f32 v53, v53
    v_cvt_pk_bf16_f32 v65, v50, v51
    v_exp_f32 v54, v54
    v_exp_f32 v55, v55
    v_cvt_pk_bf16_f32 v66, v52, v53
    v_exp_f32 v56, v56
    v_exp_f32 v57, v57
    v_cvt_pk_bf16_f32 v67, v54, v55
    v_exp_f32 v58, v58
    v_exp_f32 v59, v59
    v_cvt_pk_bf16_f32 v68, v56, v57
    v_exp_f32 v60, v60
    v_exp_f32 v61, v61
    v_cvt_pk_bf16_f32 v69, v58, v59
    v_exp_f32 v62, v62
    v_exp_f32 v63, v63
    v_cvt_pk_bf16_f32 v70, v60, v61
    v_cvt_pk_bf16_f32 v71, v62, v63
    s_setprio 0
    s_waitcnt lgkmcnt(0)
    v_mfma_f32_32x32x16_bf16 v[48:63], v[100:103], v[4:7], v[16:31]
    s_waitcnt vmcnt(0)
    s_movk_i32 s24, 0x1111
    v_cmp_eq_u32 s[100:101], 1, v135
    s_lshr_b32 s25, s100, 1
    s_and_b32 s25, s25, s100
    s_lshr_b32 s26, s25, 2
    s_and_b32 s29, s25, s26
    s_sub_u32 s25, 0, s24
    s_and_b32 s25, s25, s24
    s_and_b32 s25, s25, s29
    s_and_b32 s25, s25, s63
    s_cselect_b32 s62, 1, 0
    s_cbranch_scc0 NOE
    s_ff1_i32_b32 s26, s25
    s_bitset0_b32 s24, s26
    s_sub_u32 s25, 0, s24
    s_and_b32 s25, s25, s24
    s_and_b32 s25, s25, s29
    s_xor_b32 s26, s26, s61
    s_lshl_b32 s27, s26, 11
    s_add_u32 s27, s27, s60
    s_add_u32 s27, s27, s30
    s_xor_b32 s28, s27, 4096
    s_lshl_b32 s16, s26, 12
NOE:
    buffer_load_dwordx4 v[176:179], v1, s[8:11], s27 offen offset:0 sc1
    v_mfma_f32_32x32x16_bf16 v[72:87], v[116:119], v[64:67], v[72:87]
    v_mfma_f32_32x32x16_bf16 v[72:87], v[120:123], v[68:71], v[72:87]
    ds_read_b128 v[92:95], v128 offset:57344
    ds_read_b128 v[96:99], v128 offset:58368
    v_mfma_f32_32x32x16_bf16 v[48:63], v[104:107], v[8:11], v[48:63]
    ds_read_b128 v[116:119], v128 offset:55296
    ds_read_b128 v[120:123], v128 offset:56320
    v_smfmac_f32_16x16x64_bf16 v[88:91], v[124:127], v[64:71], v15
    buffer_load_dwordx4 v[180:183], v1, s[8:11], s27 offen offset:1024 sc1
    v_exp_f32 v32, v32
    v_exp_f32 v33, v33
    v_exp_f32 v34, v34
    v_exp_f32 v35, v35
    v_cvt_pk_bf16_f32 v64, v32, v33
    s_setprio 2
    v_exp_f32 v36, v36
    v_exp_f32 v37, v37
    v_cvt_pk_bf16_f32 v65, v34, v35
    v_exp_f32 v38, v38
    v_exp_f32 v39, v39
    v_cvt_pk_bf16_f32 v66, v36, v37
    v_exp_f32 v40, v40
    v_exp_f32 v41, v41
    v_cvt_pk_bf16_f32 v67, v38, v39
    v_exp_f32 v42, v42
    v_exp_f32 v43, v43
    v_cvt_pk_bf16_f32 v68, v40, v41
    v_exp_f32 v44, v44
    v_exp_f32 v45, v45
    v_cvt_pk_bf16_f32 v69, v42, v43
    v_exp_f32 v46, v46
    v_exp_f32 v47, v47
    v_cvt_pk_bf16_f32 v70, v44, v45
    v_cvt_pk_bf16_f32 v71, v46, v47
    s_setprio 0
    s_waitcnt lgkmcnt(0)
    v_mfma_f32_32x32x16_bf16 v[32:47], v[92:95], v[4:7], v[16:31]
    buffer_load_dwordx4 v[184:187], v1, s[8:11], s27 offen offset:2048 sc1
    v_mfma_f32_32x32x16_bf16 v[72:87], v[108:111], v[64:67], v[72:87]
    v_mfma_f32_32x32x16_bf16 v[72:87], v[112:115], v[68:71], v[72:87]
    ds_read_b128 v[100:103], v128 offset:61440
    ds_read_b128 v[104:107], v128 offset:62464
    v_mfma_f32_32x32x16_bf16 v[32:47], v[96:99], v[8:11], v[32:47]
    ds_read_b128 v[108:111], v128 offset:59392
    ds_read_b128 v[112:115], v128 offset:60416
    v_smfmac_f32_16x16x64_bf16 v[88:91], v[124:127], v[64:71], v15
    buffer_load_dwordx4 v[188:191], v1, s[8:11], s27 offen offset:3072 sc1
    v_exp_f32 v48, v48
    v_exp_f32 v49, v49
    v_exp_f32 v50, v50
    v_exp_f32 v51, v51
    v_cvt_pk_bf16_f32 v64, v48, v49
    s_setprio 2
    v_exp_f32 v52, v52
    v_exp_f32 v53, v53
    v_cvt_pk_bf16_f32 v65, v50, v51
    v_exp_f32 v54, v54
    v_exp_f32 v55, v55
    v_cvt_pk_bf16_f32 v66, v52, v53
    v_exp_f32 v56, v56
    v_exp_f32 v57, v57
    v_cvt_pk_bf16_f32 v67, v54, v55
    v_exp_f32 v58, v58
    v_exp_f32 v59, v59
    v_cvt_pk_bf16_f32 v68, v56, v57
    v_exp_f32 v60, v60
    v_exp_f32 v61, v61
    v_cvt_pk_bf16_f32 v69, v58, v59
    v_exp_f32 v62, v62
    v_exp_f32 v63, v63
    v_cvt_pk_bf16_f32 v70, v60, v61
    v_cvt_pk_bf16_f32 v71, v62, v63
    s_setprio 0
    s_waitcnt lgkmcnt(0)
    v_mfma_f32_32x32x16_bf16 v[48:63], v[100:103], v[4:7], v[16:31]
    buffer_load_dwordx4 v[192:195], v1, s[8:11], s28 offen offset:0 sc1
    v_mfma_f32_32x32x16_bf16 v[72:87], v[116:119], v[64:67], v[72:87]
    v_mfma_f32_32x32x16_bf16 v[72:87], v[120:123], v[68:71], v[72:87]
    v_mfma_f32_32x32x16_bf16 v[48:63], v[104:107], v[8:11], v[48:63]
    ds_read_b128 v[116:119], v128 offset:63488
    ds_read_b128 v[120:123], v128 offset:64512
    v_smfmac_f32_16x16x64_bf16 v[88:91], v[124:127], v[64:71], v15
    buffer_load_dwordx4 v[196:199], v1, s[8:11], s28 offen offset:1024 sc1
    v_exp_f32 v32, v32
    v_exp_f32 v33, v33
    v_exp_f32 v34, v34
    v_exp_f32 v35, v35
    v_cvt_pk_bf16_f32 v64, v32, v33
    s_setprio 2
    v_exp_f32 v36, v36
    v_exp_f32 v37, v37
    v_cvt_pk_bf16_f32 v65, v34, v35
    v_exp_f32 v38, v38
    v_exp_f32 v39, v39
    v_cvt_pk_bf16_f32 v66, v36, v37
    v_exp_f32 v40, v40
    v_exp_f32 v41, v41
    v_cvt_pk_bf16_f32 v67, v38, v39
    v_exp_f32 v42, v42
    v_exp_f32 v43, v43
    v_cvt_pk_bf16_f32 v68, v40, v41
    v_exp_f32 v44, v44
    v_exp_f32 v45, v45
    v_cvt_pk_bf16_f32 v69, v42, v43
    v_exp_f32 v46, v46
    v_exp_f32 v47, v47
    v_cvt_pk_bf16_f32 v70, v44, v45
    v_cvt_pk_bf16_f32 v71, v46, v47
    s_setprio 0
    s_waitcnt lgkmcnt(0)
    buffer_load_dwordx4 v[200:203], v1, s[8:11], s28 offen offset:2048 sc1
    v_mfma_f32_32x32x16_bf16 v[72:87], v[108:111], v[64:67], v[72:87]
    v_mfma_f32_32x32x16_bf16 v[72:87], v[112:115], v[68:71], v[72:87]
    v_smfmac_f32_16x16x64_bf16 v[88:91], v[124:127], v[64:71], v15
    buffer_load_dwordx4 v[204:207], v1, s[8:11], s28 offen offset:3072 sc1
    buffer_load_dword v135, v131, s[8:11], s59 offen sc1
    v_exp_f32 v48, v48
    v_exp_f32 v49, v49
    v_exp_f32 v50, v50
    v_exp_f32 v51, v51
    v_cvt_pk_bf16_f32 v64, v48, v49
    s_setprio 2
    v_exp_f32 v52, v52
    v_exp_f32 v53, v53
    v_cvt_pk_bf16_f32 v65, v50, v51
    v_exp_f32 v54, v54
    v_exp_f32 v55, v55
    v_cvt_pk_bf16_f32 v66, v52, v53
    v_exp_f32 v56, v56
    v_exp_f32 v57, v57
    v_cvt_pk_bf16_f32 v67, v54, v55
    v_exp_f32 v58, v58
    v_exp_f32 v59, v59
    v_cvt_pk_bf16_f32 v68, v56, v57
    v_exp_f32 v60, v60
    v_exp_f32 v61, v61
    v_cvt_pk_bf16_f32 v69, v58, v59
    v_exp_f32 v62, v62
    v_exp_f32 v63, v63
    v_cvt_pk_bf16_f32 v70, v60, v61
    v_cvt_pk_bf16_f32 v71, v62, v63
    s_setprio 0
    s_waitcnt lgkmcnt(0)
    v_mfma_f32_32x32x16_bf16 v[72:87], v[116:119], v[64:67], v[72:87]
    v_mfma_f32_32x32x16_bf16 v[72:87], v[120:123], v[68:71], v[72:87]
    v_smfmac_f32_16x16x64_bf16 v[88:91], v[124:127], v[64:71], v15
    s_mov_b32 s52, s34
    s_and_b32 s53, s35, 0xffff
    s_mov_b32 s54, 8388608
    s_mov_b32 s55, 0x00020000
    s_mov_b32 s50, 0x5d800000
    s_lshr_b32 s5, s3, 2
    s_and_b32 s4, s3, 3
    s_nop 0
    v_add_f32 v88, v88, v89
    v_cmp_nge_f32 vcc, s50, v88
    v_rcp_f32 v12, v88
    s_nop 1
    s_cbranch_vccnz P2_SLOW
P2_FIN:
    v_mul_f32 v72, v72, v12
    v_mul_f32 v73, v73, v12
    v_mul_f32 v74, v74, v12
    v_mul_f32 v75, v75, v12
    v_mul_f32 v76, v76, v12
    v_mul_f32 v77, v77, v12
    v_mul_f32 v78, v78, v12
    v_mul_f32 v79, v79, v12
    v_mul_f32 v80, v80, v12
    v_mul_f32 v81, v81, v12
    v_mul_f32 v82, v82, v12
    v_mul_f32 v83, v83, v12
    v_mul_f32 v84, v84, v12
    v_mul_f32 v85, v85, v12
    v_mul_f32 v86, v86, v12
    v_mul_f32 v87, v87, v12
    v_cvt_pk_bf16_f32 v168, v72, v73
    v_cvt_pk_bf16_f32 v169, v74, v75
    v_cvt_pk_bf16_f32 v170, v76, v77
    v_cvt_pk_bf16_f32 v171, v78, v79
    v_cvt_pk_bf16_f32 v172, v80, v81
    v_cvt_pk_bf16_f32 v173, v82, v83
    v_cvt_pk_bf16_f32 v174, v84, v85
    v_cvt_pk_bf16_f32 v175, v86, v87
    buffer_store_dwordx4 v[168:171], v1, s[8:11], s15 offen sc1
    buffer_store_dwordx4 v[172:175], v1, s[8:11], s15 offen offset:1024 sc1
    s_barrier
    ds_write_b128 v130, v[152:155] offset:0
    ds_write_b128 v130, v[156:159] offset:8192
    ds_write_b128 v130, v[160:163] offset:16384
    ds_write_b128 v130, v[164:167] offset:24576
    v_lshrrev_b32 v4, 5, v0
    v_bfe_u32 v5, v0, 2, 2
    v_lshl_add_u32 v5, v4, 2, v5
    v_lshlrev_b32 v5, 7, v5
    v_and_b32 v6, 1, v0
    v_lshl_add_u32 v5, v6, 5, v5
    v_bfe_u32 v6, v0, 4, 1
    v_lshl_add_u32 v5, v6, 4, v5
    v_bfe_u32 v6, v0, 1, 1
    v_lshl_add_u32 v5, v6, 3, v5
    v_bfe_u32 v6, v0, 3, 1
    v_xor_b32 v6, s5, v6
    v_lshl_add_u32 v5, v6, 6, v5
    s_lshl_b32 s13, s5, 16
    s_lshl1_add_u32 s13, s30, s13
    v_add_u32 v12, s13, v5
    v_xor_b32 v13, 64, v12
    s_lshl_b32 s13, s3, 12
    s_add_u32 s13, s13, 131072
    v_add_u32 v6, s13, v1
    v_xor_b32 v7, 0x4000, v6
    v_bfe_u32 v8, v0, 1, 2
    v_lshlrev_b32 v4, 1, v4
    v_xor_b32 v8, v8, v4
    v_lshlrev_b32 v8, 4, v8
    v_and_b32 v4, 31, v0
    v_lshl_add_u32 v8, v4, 6, v8
    s_xor_b32 s13, s13, 0x4000
    v_add_u32 v8, s13, v8
    v_xor_b32 v9, 16, v8
    v_bfe_u32 v4, v0, 3, 2
    v_and_b32 v5, 3, v0
    v_xor_b32 v4, v4, v5
    v_lshlrev_b32 v4, 4, v4
    v_lshrrev_b32 v5, 2, v0
    v_lshl_add_u32 v5, v5, 12, v4
    s_lshl_b32 s14, s40, 19
    s_lshl_b32 s13, s4, 17
    s_add_u32 s14, s14, s13
    s_lshl_b32 s13, s41, 7
    s_add_u32 s14, s14, s13
    s_lshl_b32 s13, s5, 6
    s_add_u32 s14, s14, s13
    s_add_u32 s14, s14, 2048
    s_add_u32 s15, s14, 65536
    s_movk_i32 s13, 0x1000
    s_mov_b32 s98, 0
    s_xor_b32 s16, s61, 0
    s_lshl_b32 s16, s16, 12
    s_xor_b32 s17, s61, 4
    s_lshl_b32 s17, s17, 12
    s_xor_b32 s18, s61, 8
    s_lshl_b32 s18, s18, 12
    s_xor_b32 s19, s61, 12
    s_lshl_b32 s19, s19, 12
    s_waitcnt vmcnt(2)
    v_cmp_eq_u32 s[100:101], 1, v135
    s_lshr_b32 s25, s100, 1
    s_and_b32 s25, s25, s100
    s_lshr_b32 s26, s25, 2
    s_and_b32 s29, s25, s26
    s_sub_u32 s25, 0, s24
    s_and_b32 s25, s25, s24
    s_and_b32 s25, s25, s29
    s_cmp_eq_u32 s62, 0
    s_cbranch_scc1 P3_W0
    s_cmp_eq_u32 s25, 0
    s_cbranch_scc1 P3_E1
    s_ff1_i32_b32 s26, s25
    s_bitset0_b32 s24, s26
    s_sub_u32 s25, 0, s24
    s_and_b32 s25, s25, s24
    s_and_b32 s25, s25, s29
    s_xor_b32 s26, s26, s61
    s_lshl_b32 s27, s26, 11
    s_add_u32 s27, s27, s60
    s_add_u32 s27, s27, s30
    s_xor_b32 s28, s27, 4096
    s_lshl_b32 s17, s26, 12
    buffer_load_dwordx4 v[208:211], v1, s[8:11], s27 offen offset:0 sc1
    buffer_load_dwordx4 v[212:215], v1, s[8:11], s27 offen offset:1024 sc1
    buffer_load_dwordx4 v[216:219], v1, s[8:11], s27 offen offset:2048 sc1
    buffer_load_dwordx4 v[220:223], v1, s[8:11], s27 offen offset:3072 sc1
    buffer_load_dwordx4 v[224:227], v1, s[8:11], s28 offen offset:0 sc1
    buffer_load_dwordx4 v[228:231], v1, s[8:11], s28 offen offset:1024 sc1
    buffer_load_dwordx4 v[232:235], v1, s[8:11], s28 offen offset:2048 sc1
    buffer_load_dwordx4 v[236:239], v1, s[8:11], s28 offen offset:3072 sc1
    s_mov_b32 s62, 2
P3_E1:
    v_add_u32 v14, s16, v12
    v_add_u32 v15, s16, v13
    v_xor_b32 v10, 0x2000, v14
    v_xor_b32 v11, 0x2000, v15
    ds_read_b64_tr_b16 v[16:17], v14 offset:0
    ds_read_b64_tr_b16 v[18:19], v14 offset:1024
    ds_read_b64_tr_b16 v[20:21], v15 offset:0
    ds_read_b64_tr_b16 v[22:23], v15 offset:1024
    ds_read_b64_tr_b16 v[24:25], v14 offset:2048
    ds_read_b64_tr_b16 v[26:27], v14 offset:3072
    ds_read_b64_tr_b16 v[28:29], v15 offset:2048
    ds_read_b64_tr_b16 v[30:31], v15 offset:3072
    ds_read_b64_tr_b16 v[152:153], v14 offset:4096
    ds_read_b64_tr_b16 v[154:155], v14 offset:5120
    ds_read_b64_tr_b16 v[156:157], v15 offset:4096
    ds_read_b64_tr_b16 v[158:159], v15 offset:5120
    s_waitcnt lgkmcnt(8)
    v_mfma_f32_32x32x16_bf16 v[32:47], v[16:19], v[176:179], 0
    v_mfma_f32_32x32x16_bf16 v[48:63], v[20:23], v[176:179], 0
    ds_read_b64_tr_b16 v[16:17], v14 offset:6144
    ds_read_b64_tr_b16 v[18:19], v14 offset:7168
    ds_read_b64_tr_b16 v[20:21], v15 offset:6144
    ds_read_b64_tr_b16 v[22:23], v15 offset:7168
    s_waitcnt lgkmcnt(8)
    v_mfma_f32_32x32x16_bf16 v[32:47], v[24:27], v[180:183], v[32:47]
    v_mfma_f32_32x32x16_bf16 v[48:63], v[28:31], v[180:183], v[48:63]
    ds_read_b64_tr_b16 v[24:25], v10 offset:0
    ds_read_b64_tr_b16 v[26:27], v10 offset:1024
    ds_read_b64_tr_b16 v[28:29], v11 offset:0
    ds_read_b64_tr_b16 v[30:31], v11 offset:1024
    s_waitcnt lgkmcnt(8)
    v_mfma_f32_32x32x16_bf16 v[32:47], v[152:155], v[184:187], v[32:47]
    v_mfma_f32_32x32x16_bf16 v[48:63], v[156:159], v[184:187], v[48:63]
    ds_read_b64_tr_b16 v[152:153], v10 offset:2048
    ds_read_b64_tr_b16 v[154:155], v10 offset:3072
    ds_read_b64_tr_b16 v[156:157], v11 offset:2048
    ds_read_b64_tr_b16 v[158:159], v11 offset:3072
    v_add_u32 v14, s17, v12
    v_add_u32 v15, s17, v13
    s_waitcnt lgkmcnt(8)
    v_mfma_f32_32x32x16_bf16 v[32:47], v[16:19], v[188:191], v[32:47]
    v_mfma_f32_32x32x16_bf16 v[48:63], v[20:23], v[188:191], v[48:63]
    ds_read_b64_tr_b16 v[16:17], v10 offset:4096
    ds_read_b64_tr_b16 v[18:19], v10 offset:5120
    ds_read_b64_tr_b16 v[20:21], v11 offset:4096
    ds_read_b64_tr_b16 v[22:23], v11 offset:5120
    s_waitcnt lgkmcnt(8)
    v_mfma_f32_32x32x16_bf16 v[32:47], v[24:27], v[192:195], v[32:47]
    v_mfma_f32_32x32x16_bf16 v[48:63], v[28:31], v[192:195], v[48:63]
    ds_read_b64_tr_b16 v[24:25], v10 offset:6144
    ds_read_b64_tr_b16 v[26:27], v10 offset:7168
    ds_read_b64_tr_b16 v[28:29], v11 offset:6144
    ds_read_b64_tr_b16 v[30:31], v11 offset:7168
    s_waitcnt lgkmcnt(8)
    v_mfma_f32_32x32x16_bf16 v[32:47], v[152:155], v[196:199], v[32:47]
    v_mfma_f32_32x32x16_bf16 v[48:63], v[156:159], v[196:199], v[48:63]
    ds_read_b64_tr_b16 v[152:153], v14 offset:0
    ds_read_b64_tr_b16 v[154:155], v14 offset:1024
    ds_read_b64_tr_b16 v[156:157], v15 offset:0
    ds_read_b64_tr_b16 v[158:159], v15 offset:1024
    s_waitcnt lgkmcnt(8)
    v_mfma_f32_32x32x16_bf16 v[32:47], v[16:19], v[200:203], v[32:47]
    v_mfma_f32_32x32x16_bf16 v[48:63], v[20:23], v[200:203], v[48:63]
    ds_read_b64_tr_b16 v[16:17], v14 offset:2048
    ds_read_b64_tr_b16 v[18:19], v14 offset:3072
    ds_read_b64_tr_b16 v[20:21], v15 offset:2048
    ds_read_b64_tr_b16 v[22:23], v15 offset:3072
    s_waitcnt lgkmcnt(8)
    v_mfma_f32_32x32x16_bf16 v[32:47], v[24:27], v[204:207], v[32:47]
    v_mfma_f32_32x32x16_bf16 v[48:63], v[28:31], v[204:207], v[48:63]
    s_cmp_eq_u32 s62, 2
    s_cbranch_scc1 P3_E2
    s_waitcnt vmcnt(0)
P3_E2:
    s_waitcnt vmcnt(8)
    s_barrier
    s_mov_b64 exec, 1
    v_mov_b32 v3, 1
    buffer_store_dword v3, v2, s[8:11], s58 offen sc1
    s_mov_b64 exec, -1
    s_cmp_eq_u32 s62, 2
    s_cbranch_scc1 TRY_1_2
    s_branch TRY_1_1
P3_W0:
    s_waitcnt vmcnt(0) lgkmcnt(0)
    s_barrier
    s_mov_b64 exec, 1
    v_mov_b32 v3, 1
    buffer_store_dword v3, v2, s[8:11], s58 offen sc1
    s_mov_b64 exec, -1
TRY_0_0:
    s_cmp_lg_u32 s25, 0
    s_cbranch_scc1 ISS_0_0
POL_0:
    buffer_load_dword v135, v131, s[8:11], s59 offen sc1
    s_waitcnt vmcnt(0)
    v_cmp_eq_u32 s[100:101], 1, v135
    s_lshr_b32 s25, s100, 1
    s_and_b32 s25, s25, s100
    s_lshr_b32 s26, s25, 2
    s_and_b32 s29, s25, s26
    s_sub_u32 s25, 0, s24
    s_and_b32 s25, s25, s24
    s_and_b32 s25, s25, s29
    s_cbranch_scc1 ISS_0_0
    s_sleep 3
    s_add_u32 s98, s98, 1
    s_cmp_lt_u32 s98, 0x80000
    s_cbranch_scc1 POL_0
    s_branch P3_RED
ISS_0_0:
    s_ff1_i32_b32 s26, s25
    s_bitset0_b32 s24, s26
    s_sub_u32 s25, 0, s24
    s_and_b32 s25, s25, s24
    s_and_b32 s25, s25, s29
    s_xor_b32 s26, s26, s61
    s_lshl_b32 s27, s26, 11
    s_add_u32 s27, s27, s60
    s_add_u32 s27, s27, s30
    s_xor_b32 s28, s27, 4096
    s_lshl_b32 s16, s26, 12
    buffer_load_dwordx4 v[176:179], v1, s[8:11], s27 offen offset:0 sc1
    buffer_load_dwordx4 v[180:183], v1, s[8:11], s27 offen offset:1024 sc1
    buffer_load_dwordx4 v[184:187], v1, s[8:11], s27 offen offset:2048 sc1
    buffer_load_dwordx4 v[188:191], v1, s[8:11], s27 offen offset:3072 sc1
    buffer_load_dwordx4 v[192:195], v1, s[8:11], s28 offen offset:0 sc1
    buffer_load_dwordx4 v[196:199], v1, s[8:11], s28 offen offset:1024 sc1
    buffer_load_dwordx4 v[200:203], v1, s[8:11], s28 offen offset:2048 sc1
    buffer_load_dwordx4 v[204:207], v1, s[8:11], s28 offen offset:3072 sc1
    s_branch TRY_0_1
TRY_0_1:
    s_cmp_lg_u32 s25, 0
    s_cbranch_scc1 ISS_0_1
    buffer_load_dword v135, v131, s[8:11], s59 offen sc1
    v_add_u32 v14, s16, v12
    v_add_u32 v15, s16, v13
    v_xor_b32 v10, 0x2000, v14
    v_xor_b32 v11, 0x2000, v15
    ds_read_b64_tr_b16 v[16:17], v14 offset:0
    ds_read_b64_tr_b16 v[18:19], v14 offset:1024
    ds_read_b64_tr_b16 v[20:21], v15 offset:0
    ds_read_b64_tr_b16 v[22:23], v15 offset:1024
    ds_read_b64_tr_b16 v[24:25], v14 offset:2048
    ds_read_b64_tr_b16 v[26:27], v14 offset:3072
    ds_read_b64_tr_b16 v[28:29], v15 offset:2048
    ds_read_b64_tr_b16 v[30:31], v15 offset:3072
    ds_read_b64_tr_b16 v[152:153], v14 offset:4096
    ds_read_b64_tr_b16 v[154:155], v14 offset:5120
    ds_read_b64_tr_b16 v[156:157], v15 offset:4096
    ds_read_b64_tr_b16 v[158:159], v15 offset:5120
    s_waitcnt vmcnt(8) lgkmcnt(8)
    v_mfma_f32_32x32x16_bf16 v[32:47], v[16:19], v[176:179], 0
    v_mfma_f32_32x32x16_bf16 v[48:63], v[20:23], v[176:179], 0
    ds_read_b64_tr_b16 v[16:17], v14 offset:6144
    ds_read_b64_tr_b16 v[18:19], v14 offset:7168
    ds_read_b64_tr_b16 v[20:21], v15 offset:6144
    ds_read_b64_tr_b16 v[22:23], v15 offset:7168
    s_waitcnt vmcnt(7) lgkmcnt(8)
    v_mfma_f32_32x32x16_bf16 v[32:47], v[24:27], v[180:183], v[32:47]
    v_mfma_f32_32x32x16_bf16 v[48:63], v[28:31], v[180:183], v[48:63]
    ds_read_b64_tr_b16 v[24:25], v10 offset:0
    ds_read_b64_tr_b16 v[26:27], v10 offset:1024
    ds_read_b64_tr_b16 v[28:29], v11 offset:0
    ds_read_b64_tr_b16 v[30:31], v11 offset:1024
    s_waitcnt vmcnt(6) lgkmcnt(8)
    v_mfma_f32_32x32x16_bf16 v[32:47], v[152:155], v[184:187], v[32:47]
    v_mfma_f32_32x32x16_bf16 v[48:63], v[156:159], v[184:187], v[48:63]
    ds_read_b64_tr_b16 v[152:153], v10 offset:2048
    ds_read_b64_tr_b16 v[154:155], v10 offset:3072
    ds_read_b64_tr_b16 v[156:157], v11 offset:2048
    ds_read_b64_tr_b16 v[158:159], v11 offset:3072
    v_add_u32 v14, s17, v12
    v_add_u32 v15, s17, v13
    s_waitcnt vmcnt(5) lgkmcnt(8)
    v_mfma_f32_32x32x16_bf16 v[32:47], v[16:19], v[188:191], v[32:47]
    v_mfma_f32_32x32x16_bf16 v[48:63], v[20:23], v[188:191], v[48:63]
    ds_read_b64_tr_b16 v[16:17], v10 offset:4096
    ds_read_b64_tr_b16 v[18:19], v10 offset:5120
    ds_read_b64_tr_b16 v[20:21], v11 offset:4096
    ds_read_b64_tr_b16 v[22:23], v11 offset:5120
    s_waitcnt vmcnt(4) lgkmcnt(8)
    v_mfma_f32_32x32x16_bf16 v[32:47], v[24:27], v[192:195], v[32:47]
    v_mfma_f32_32x32x16_bf16 v[48:63], v[28:31], v[192:195], v[48:63]
    ds_read_b64_tr_b16 v[24:25], v10 offset:6144
    ds_read_b64_tr_b16 v[26:27], v10 offset:7168
    ds_read_b64_tr_b16 v[28:29], v11 offset:6144
    ds_read_b64_tr_b16 v[30:31], v11 offset:7168
    s_waitcnt vmcnt(3) lgkmcnt(8)
    v_mfma_f32_32x32x16_bf16 v[32:47], v[152:155], v[196:199], v[32:47]
    v_mfma_f32_32x32x16_bf16 v[48:63], v[156:159], v[196:199], v[48:63]
    ds_read_b64_tr_b16 v[152:153], v14 offset:0
    ds_read_b64_tr_b16 v[154:155], v14 offset:1024
    ds_read_b64_tr_b16 v[156:157], v15 offset:0
    ds_read_b64_tr_b16 v[158:159], v15 offset:1024
    s_waitcnt vmcnt(2) lgkmcnt(8)
    v_mfma_f32_32x32x16_bf16 v[32:47], v[16:19], v[200:203], v[32:47]
    v_mfma_f32_32x32x16_bf16 v[48:63], v[20:23], v[200:203], v[48:63]
    ds_read_b64_tr_b16 v[16:17], v14 offset:2048
    ds_read_b64_tr_b16 v[18:19], v14 offset:3072
    ds_read_b64_tr_b16 v[20:21], v15 offset:2048
    ds_read_b64_tr_b16 v[22:23], v15 offset:3072
    s_waitcnt vmcnt(1) lgkmcnt(8)
    v_mfma_f32_32x32x16_bf16 v[32:47], v[24:27], v[204:207], v[32:47]
    v_mfma_f32_32x32x16_bf16 v[48:63], v[28:31], v[204:207], v[48:63]
    s_cmp_lg_u32 s25, 0
    s_cbranch_scc1 ISS_1_1
    s_waitcnt vmcnt(0)
    v_cmp_eq_u32 s[100:101], 1, v135
    s_lshr_b32 s25, s100, 1
    s_and_b32 s25, s25, s100
    s_lshr_b32 s26, s25, 2
    s_and_b32 s29, s25, s26
    s_sub_u32 s25, 0, s24
    s_and_b32 s25, s25, s24
    s_and_b32 s25, s25, s29
    s_branch TRY_1_1
ISS_0_1:
    s_ff1_i32_b32 s26, s25
    s_bitset0_b32 s24, s26
    s_sub_u32 s25, 0, s24
    s_and_b32 s25, s25, s24
    s_and_b32 s25, s25, s29
    s_xor_b32 s26, s26, s61
    s_lshl_b32 s27, s26, 11
    s_add_u32 s27, s27, s60
    s_add_u32 s27, s27, s30
    s_xor_b32 s28, s27, 4096
    s_lshl_b32 s17, s26, 12
    buffer_load_dwordx4 v[208:211], v1, s[8:11], s27 offen offset:0 sc1
    buffer_load_dwordx4 v[212:215], v1, s[8:11], s27 offen offset:1024 sc1
    buffer_load_dwordx4 v[216:219], v1, s[8:11], s27 offen offset:2048 sc1
    buffer_load_dwordx4 v[220:223], v1, s[8:11], s27 offen offset:3072 sc1
    buffer_load_dwordx4 v[224:227], v1, s[8:11], s28 offen offset:0 sc1
    buffer_load_dwordx4 v[228:231], v1, s[8:11], s28 offen offset:1024 sc1
    buffer_load_dwordx4 v[232:235], v1, s[8:11], s28 offen offset:2048 sc1
    buffer_load_dwordx4 v[236:239], v1, s[8:11], s28 offen offset:3072 sc1
    s_branch TRY_0_2
TRY_1_1:
    s_cmp_lg_u32 s25, 0
    s_cbranch_scc1 ISS_1_1
POL_1:
    buffer_load_dword v135, v131, s[8:11], s59 offen sc1
    s_waitcnt vmcnt(0)
    v_cmp_eq_u32 s[100:101], 1, v135
    s_lshr_b32 s25, s100, 1
    s_and_b32 s25, s25, s100
    s_lshr_b32 s26, s25, 2
    s_and_b32 s29, s25, s26
    s_sub_u32 s25, 0, s24
    s_and_b32 s25, s25, s24
    s_and_b32 s25, s25, s29
    s_cbranch_scc1 ISS_1_1
    s_sleep 3
    s_add_u32 s98, s98, 1
    s_cmp_lt_u32 s98, 0x80000
    s_cbranch_scc1 POL_1
    s_branch P3_RED
ISS_1_1:
    s_ff1_i32_b32 s26, s25
    s_bitset0_b32 s24, s26
    s_sub_u32 s25, 0, s24
    s_and_b32 s25, s25, s24
    s_and_b32 s25, s25, s29
    s_xor_b32 s26, s26, s61
    s_lshl_b32 s27, s26, 11
    s_add_u32 s27, s27, s60
    s_add_u32 s27, s27, s30
    s_xor_b32 s28, s27, 4096
    s_lshl_b32 s17, s26, 12
    buffer_load_dwordx4 v[208:211], v1, s[8:11], s27 offen offset:0 sc1
    buffer_load_dwordx4 v[212:215], v1, s[8:11], s27 offen offset:1024 sc1
    buffer_load_dwordx4 v[216:219], v1, s[8:11], s27 offen offset:2048 sc1
    buffer_load_dwordx4 v[220:223], v1, s[8:11], s27 offen offset:3072 sc1
    buffer_load_dwordx4 v[224:227], v1, s[8:11], s28 offen offset:0 sc1
    buffer_load_dwordx4 v[228:231], v1, s[8:11], s28 offen offset:1024 sc1
    buffer_load_dwordx4 v[232:235], v1, s[8:11], s28 offen offset:2048 sc1
    buffer_load_dwordx4 v[236:239], v1, s[8:11], s28 offen offset:3072 sc1
    s_branch TRY_1_2
TRY_0_2:
    buffer_load_dword v135, v131, s[8:11], s59 offen sc1
    v_add_u32 v14, s16, v12
    v_add_u32 v15, s16, v13
    v_xor_b32 v10, 0x2000, v14
    v_xor_b32 v11, 0x2000, v15
    ds_read_b64_tr_b16 v[16:17], v14 offset:0
    ds_read_b64_tr_b16 v[18:19], v14 offset:1024
    ds_read_b64_tr_b16 v[20:21], v15 offset:0
    ds_read_b64_tr_b16 v[22:23], v15 offset:1024
    ds_read_b64_tr_b16 v[24:25], v14 offset:2048
    ds_read_b64_tr_b16 v[26:27], v14 offset:3072
    ds_read_b64_tr_b16 v[28:29], v15 offset:2048
    ds_read_b64_tr_b16 v[30:31], v15 offset:3072
    ds_read_b64_tr_b16 v[152:153], v14 offset:4096
    ds_read_b64_tr_b16 v[154:155], v14 offset:5120
    ds_read_b64_tr_b16 v[156:157], v15 offset:4096
    ds_read_b64_tr_b16 v[158:159], v15 offset:5120
    s_waitcnt vmcnt(16) lgkmcnt(8)
    v_mfma_f32_32x32x16_bf16 v[32:47], v[16:19], v[176:179], 0
    v_mfma_f32_32x32x16_bf16 v[48:63], v[20:23], v[176:179], 0
    ds_read_b64_tr_b16 v[16:17], v14 offset:6144
    ds_read_b64_tr_b16 v[18:19], v14 offset:7168
    ds_read_b64_tr_b16 v[20:21], v15 offset:6144
    ds_read_b64_tr_b16 v[22:23], v15 offset:7168
    s_waitcnt vmcnt(15) lgkmcnt(8)
    v_mfma_f32_32x32x16_bf16 v[32:47], v[24:27], v[180:183], v[32:47]
    v_mfma_f32_32x32x16_bf16 v[48:63], v[28:31], v[180:183], v[48:63]
    ds_read_b64_tr_b16 v[24:25], v10 offset:0
    ds_read_b64_tr_b16 v[26:27], v10 offset:1024
    ds_read_b64_tr_b16 v[28:29], v11 offset:0
    ds_read_b64_tr_b16 v[30:31], v11 offset:1024
    s_waitcnt vmcnt(14) lgkmcnt(8)
    v_mfma_f32_32x32x16_bf16 v[32:47], v[152:155], v[184:187], v[32:47]
    v_mfma_f32_32x32x16_bf16 v[48:63], v[156:159], v[184:187], v[48:63]
    ds_read_b64_tr_b16 v[152:153], v10 offset:2048
    ds_read_b64_tr_b16 v[154:155], v10 offset:3072
    ds_read_b64_tr_b16 v[156:157], v11 offset:2048
    ds_read_b64_tr_b16 v[158:159], v11 offset:3072
    v_add_u32 v14, s17, v12
    v_add_u32 v15, s17, v13
    s_waitcnt vmcnt(13) lgkmcnt(8)
    v_mfma_f32_32x32x16_bf16 v[32:47], v[16:19], v[188:191], v[32:47]
    v_mfma_f32_32x32x16_bf16 v[48:63], v[20:23], v[188:191], v[48:63]
    ds_read_b64_tr_b16 v[16:17], v10 offset:4096
    ds_read_b64_tr_b16 v[18:19], v10 offset:5120
    ds_read_b64_tr_b16 v[20:21], v11 offset:4096
    ds_read_b64_tr_b16 v[22:23], v11 offset:5120
    s_waitcnt vmcnt(12) lgkmcnt(8)
    v_mfma_f32_32x32x16_bf16 v[32:47], v[24:27], v[192:195], v[32:47]
    v_mfma_f32_32x32x16_bf16 v[48:63], v[28:31], v[192:195], v[48:63]
    ds_read_b64_tr_b16 v[24:25], v10 offset:6144
    ds_read_b64_tr_b16 v[26:27], v10 offset:7168
    ds_read_b64_tr_b16 v[28:29], v11 offset:6144
    ds_read_b64_tr_b16 v[30:31], v11 offset:7168
    s_waitcnt vmcnt(11) lgkmcnt(8)
    v_mfma_f32_32x32x16_bf16 v[32:47], v[152:155], v[196:199], v[32:47]
    v_mfma_f32_32x32x16_bf16 v[48:63], v[156:159], v[196:199], v[48:63]
    ds_read_b64_tr_b16 v[152:153], v14 offset:0
    ds_read_b64_tr_b16 v[154:155], v14 offset:1024
    ds_read_b64_tr_b16 v[156:157], v15 offset:0
    ds_read_b64_tr_b16 v[158:159], v15 offset:1024
    s_waitcnt vmcnt(10) lgkmcnt(8)
    v_mfma_f32_32x32x16_bf16 v[32:47], v[16:19], v[200:203], v[32:47]
    v_mfma_f32_32x32x16_bf16 v[48:63], v[20:23], v[200:203], v[48:63]
    ds_read_b64_tr_b16 v[16:17], v14 offset:2048
    ds_read_b64_tr_b16 v[18:19], v14 offset:3072
    ds_read_b64_tr_b16 v[20:21], v15 offset:2048
    ds_read_b64_tr_b16 v[22:23], v15 offset:3072
    s_waitcnt vmcnt(9) lgkmcnt(8)
    v_mfma_f32_32x32x16_bf16 v[32:47], v[24:27], v[204:207], v[32:47]
    v_mfma_f32_32x32x16_bf16 v[48:63], v[28:31], v[204:207], v[48:63]
    s_cmp_lg_u32 s25, 0
    s_cbranch_scc1 ISS_1_2
    s_waitcnt vmcnt(0)
    v_cmp_eq_u32 s[100:101], 1, v135
    s_lshr_b32 s25, s100, 1
    s_and_b32 s25, s25, s100
    s_lshr_b32 s26, s25, 2
    s_and_b32 s29, s25, s26
    s_sub_u32 s25, 0, s24
    s_and_b32 s25, s25, s24
    s_and_b32 s25, s25, s29
    s_branch TRY_1_2
TRY_1_2:
    s_cmp_lg_u32 s25, 0
    s_cbranch_scc1 ISS_1_2
    buffer_load_dword v135, v131, s[8:11], s59 offen sc1
    v_xor_b32 v10, 0x2000, v14
    v_xor_b32 v11, 0x2000, v15
    ds_read_b64_tr_b16 v[24:25], v14 offset:4096
    ds_read_b64_tr_b16 v[26:27], v14 offset:5120
    ds_read_b64_tr_b16 v[28:29], v15 offset:4096
    ds_read_b64_tr_b16 v[30:31], v15 offset:5120
    s_waitcnt vmcnt(8) lgkmcnt(8)
    v_mfma_f32_32x32x16_bf16 v[32:47], v[152:155], v[208:211], v[32:47]
    v_mfma_f32_32x32x16_bf16 v[48:63], v[156:159], v[208:211], v[48:63]
    ds_read_b64_tr_b16 v[152:153], v14 offset:6144
    ds_read_b64_tr_b16 v[154:155], v14 offset:7168
    ds_read_b64_tr_b16 v[156:157], v15 offset:6144
    ds_read_b64_tr_b16 v[158:159], v15 offset:7168
    s_waitcnt vmcnt(7) lgkmcnt(8)
    v_mfma_f32_32x32x16_bf16 v[32:47], v[16:19], v[212:215], v[32:47]
    v_mfma_f32_32x32x16_bf16 v[48:63], v[20:23], v[212:215], v[48:63]
    ds_read_b64_tr_b16 v[16:17], v10 offset:0
    ds_read_b64_tr_b16 v[18:19], v10 offset:1024
    ds_read_b64_tr_b16 v[20:21], v11 offset:0
    ds_read_b64_tr_b16 v[22:23], v11 offset:1024
    s_waitcnt vmcnt(6) lgkmcnt(8)
    v_mfma_f32_32x32x16_bf16 v[32:47], v[24:27], v[216:219], v[32:47]
    v_mfma_f32_32x32x16_bf16 v[48:63], v[28:31], v[216:219], v[48:63]
    ds_read_b64_tr_b16 v[24:25], v10 offset:2048
    ds_read_b64_tr_b16 v[26:27], v10 offset:3072
    ds_read_b64_tr_b16 v[28:29], v11 offset:2048
    ds_read_b64_tr_b16 v[30:31], v11 offset:3072
    v_add_u32 v14, s18, v12
    v_add_u32 v15, s18, v13
    s_waitcnt vmcnt(5) lgkmcnt(8)
    v_mfma_f32_32x32x16_bf16 v[32:47], v[152:155], v[220:223], v[32:47]
    v_mfma_f32_32x32x16_bf16 v[48:63], v[156:159], v[220:223], v[48:63]
    ds_read_b64_tr_b16 v[152:153], v10 offset:4096
    ds_read_b64_tr_b16 v[154:155], v10 offset:5120
    ds_read_b64_tr_b16 v[156:157], v11 offset:4096
    ds_read_b64_tr_b16 v[158:159], v11 offset:5120
    s_waitcnt vmcnt(4) lgkmcnt(8)
    v_mfma_f32_32x32x16_bf16 v[32:47], v[16:19], v[224:227], v[32:47]
    v_mfma_f32_32x32x16_bf16 v[48:63], v[20:23], v[224:227], v[48:63]
    ds_read_b64_tr_b16 v[16:17], v10 offset:6144
    ds_read_b64_tr_b16 v[18:19], v10 offset:7168
    ds_read_b64_tr_b16 v[20:21], v11 offset:6144
    ds_read_b64_tr_b16 v[22:23], v11 offset:7168
    s_waitcnt vmcnt(3) lgkmcnt(8)
    v_mfma_f32_32x32x16_bf16 v[32:47], v[24:27], v[228:231], v[32:47]
    v_mfma_f32_32x32x16_bf16 v[48:63], v[28:31], v[228:231], v[48:63]
    ds_read_b64_tr_b16 v[24:25], v14 offset:0
    ds_read_b64_tr_b16 v[26:27], v14 offset:1024
    ds_read_b64_tr_b16 v[28:29], v15 offset:0
    ds_read_b64_tr_b16 v[30:31], v15 offset:1024
    s_waitcnt vmcnt(2) lgkmcnt(8)
    v_mfma_f32_32x32x16_bf16 v[32:47], v[152:155], v[232:235], v[32:47]
    v_mfma_f32_32x32x16_bf16 v[48:63], v[156:159], v[232:235], v[48:63]
    ds_read_b64_tr_b16 v[152:153], v14 offset:2048
    ds_read_b64_tr_b16 v[154:155], v14 offset:3072
    ds_read_b64_tr_b16 v[156:157], v15 offset:2048
    ds_read_b64_tr_b16 v[158:159], v15 offset:3072
    s_waitcnt vmcnt(1) lgkmcnt(8)
    v_mfma_f32_32x32x16_bf16 v[32:47], v[16:19], v[236:239], v[32:47]
    v_mfma_f32_32x32x16_bf16 v[48:63], v[20:23], v[236:239], v[48:63]
    s_cmp_lg_u32 s25, 0
    s_cbranch_scc1 ISS_2_2
    s_waitcnt vmcnt(0)
    v_cmp_eq_u32 s[100:101], 1, v135
    s_lshr_b32 s25, s100, 1
    s_and_b32 s25, s25, s100
    s_lshr_b32 s26, s25, 2
    s_and_b32 s29, s25, s26
    s_sub_u32 s25, 0, s24
    s_and_b32 s25, s25, s24
    s_and_b32 s25, s25, s29
    s_branch TRY_2_2
ISS_1_2:
    s_ff1_i32_b32 s26, s25
    s_bitset0_b32 s24, s26
    s_sub_u32 s25, 0, s24
    s_and_b32 s25, s25, s24
    s_and_b32 s25, s25, s29
    s_xor_b32 s26, s26, s61
    s_lshl_b32 s27, s26, 11
    s_add_u32 s27, s27, s60
    s_add_u32 s27, s27, s30
    s_xor_b32 s28, s27, 4096
    s_lshl_b32 s18, s26, 12
    buffer_load_dwordx4 v[64:67], v1, s[8:11], s27 offen offset:0 sc1
    buffer_load_dwordx4 v[68:71], v1, s[8:11], s27 offen offset:1024 sc1
    buffer_load_dwordx4 v[72:75], v1, s[8:11], s27 offen offset:2048 sc1
    buffer_load_dwordx4 v[76:79], v1, s[8:11], s27 offen offset:3072 sc1
    buffer_load_dwordx4 v[80:83], v1, s[8:11], s28 offen offset:0 sc1
    buffer_load_dwordx4 v[84:87], v1, s[8:11], s28 offen offset:1024 sc1
    buffer_load_dwordx4 v[88:91], v1, s[8:11], s28 offen offset:2048 sc1
    buffer_load_dwordx4 v[92:95], v1, s[8:11], s28 offen offset:3072 sc1
    s_branch TRY_1_3
TRY_2_2:
    s_cmp_lg_u32 s25, 0
    s_cbranch_scc1 ISS_2_2
POL_2:
    buffer_load_dword v135, v131, s[8:11], s59 offen sc1
    s_waitcnt vmcnt(0)
    v_cmp_eq_u32 s[100:101], 1, v135
    s_lshr_b32 s25, s100, 1
    s_and_b32 s25, s25, s100
    s_lshr_b32 s26, s25, 2
    s_and_b32 s29, s25, s26
    s_sub_u32 s25, 0, s24
    s_and_b32 s25, s25, s24
    s_and_b32 s25, s25, s29
    s_cbranch_scc1 ISS_2_2
    s_sleep 3
    s_add_u32 s98, s98, 1
    s_cmp_lt_u32 s98, 0x80000
    s_cbranch_scc1 POL_2
    s_branch P3_RED
ISS_2_2:
    s_ff1_i32_b32 s26, s25
    s_bitset0_b32 s24, s26
    s_sub_u32 s25, 0, s24
    s_and_b32 s25, s25, s24
    s_and_b32 s25, s25, s29
    s_xor_b32 s26, s26, s61
    s_lshl_b32 s27, s26, 11
    s_add_u32 s27, s27, s60
    s_add_u32 s27, s27, s30
    s_xor_b32 s28, s27, 4096
    s_lshl_b32 s18, s26, 12
    buffer_load_dwordx4 v[64:67], v1, s[8:11], s27 offen offset:0 sc1
    buffer_load_dwordx4 v[68:71], v1, s[8:11], s27 offen offset:1024 sc1
    buffer_load_dwordx4 v[72:75], v1, s[8:11], s27 offen offset:2048 sc1
    buffer_load_dwordx4 v[76:79], v1, s[8:11], s27 offen offset:3072 sc1
    buffer_load_dwordx4 v[80:83], v1, s[8:11], s28 offen offset:0 sc1
    buffer_load_dwordx4 v[84:87], v1, s[8:11], s28 offen offset:1024 sc1
    buffer_load_dwordx4 v[88:91], v1, s[8:11], s28 offen offset:2048 sc1
    buffer_load_dwordx4 v[92:95], v1, s[8:11], s28 offen offset:3072 sc1
    s_branch TRY_2_3
TRY_1_3:
    buffer_load_dword v135, v131, s[8:11], s59 offen sc1
    v_xor_b32 v10, 0x2000, v14
    v_xor_b32 v11, 0x2000, v15
    ds_read_b64_tr_b16 v[24:25], v14 offset:4096
    ds_read_b64_tr_b16 v[26:27], v14 offset:5120
    ds_read_b64_tr_b16 v[28:29], v15 offset:4096
    ds_read_b64_tr_b16 v[30:31], v15 offset:5120
    s_waitcnt vmcnt(16) lgkmcnt(8)
    v_mfma_f32_32x32x16_bf16 v[32:47], v[152:155], v[208:211], v[32:47]
    v_mfma_f32_32x32x16_bf16 v[48:63], v[156:159], v[208:211], v[48:63]
    ds_read_b64_tr_b16 v[152:153], v14 offset:6144
    ds_read_b64_tr_b16 v[154:155], v14 offset:7168
    ds_read_b64_tr_b16 v[156:157], v15 offset:6144
    ds_read_b64_tr_b16 v[158:159], v15 offset:7168
    s_waitcnt vmcnt(15) lgkmcnt(8)
    v_mfma_f32_32x32x16_bf16 v[32:47], v[16:19], v[212:215], v[32:47]
    v_mfma_f32_32x32x16_bf16 v[48:63], v[20:23], v[212:215], v[48:63]
    ds_read_b64_tr_b16 v[16:17], v10 offset:0
    ds_read_b64_tr_b16 v[18:19], v10 offset:1024
    ds_read_b64_tr_b16 v[20:21], v11 offset:0
    ds_read_b64_tr_b16 v[22:23], v11 offset:1024
    s_waitcnt vmcnt(14) lgkmcnt(8)
    v_mfma_f32_32x32x16_bf16 v[32:47], v[24:27], v[216:219], v[32:47]
    v_mfma_f32_32x32x16_bf16 v[48:63], v[28:31], v[216:219], v[48:63]
    ds_read_b64_tr_b16 v[24:25], v10 offset:2048
    ds_read_b64_tr_b16 v[26:27], v10 offset:3072
    ds_read_b64_tr_b16 v[28:29], v11 offset:2048
    ds_read_b64_tr_b16 v[30:31], v11 offset:3072
    v_add_u32 v14, s18, v12
    v_add_u32 v15, s18, v13
    s_waitcnt vmcnt(13) lgkmcnt(8)
    v_mfma_f32_32x32x16_bf16 v[32:47], v[152:155], v[220:223], v[32:47]
    v_mfma_f32_32x32x16_bf16 v[48:63], v[156:159], v[220:223], v[48:63]
    ds_read_b64_tr_b16 v[152:153], v10 offset:4096
    ds_read_b64_tr_b16 v[154:155], v10 offset:5120
    ds_read_b64_tr_b16 v[156:157], v11 offset:4096
    ds_read_b64_tr_b16 v[158:159], v11 offset:5120
    s_waitcnt vmcnt(12) lgkmcnt(8)
    v_mfma_f32_32x32x16_bf16 v[32:47], v[16:19], v[224:227], v[32:47]
    v_mfma_f32_32x32x16_bf16 v[48:63], v[20:23], v[224:227], v[48:63]
    ds_read_b64_tr_b16 v[16:17], v10 offset:6144
    ds_read_b64_tr_b16 v[18:19], v10 offset:7168
    ds_read_b64_tr_b16 v[20:21], v11 offset:6144
    ds_read_b64_tr_b16 v[22:23], v11 offset:7168
    s_waitcnt vmcnt(11) lgkmcnt(8)
    v_mfma_f32_32x32x16_bf16 v[32:47], v[24:27], v[228:231], v[32:47]
    v_mfma_f32_32x32x16_bf16 v[48:63], v[28:31], v[228:231], v[48:63]
    ds_read_b64_tr_b16 v[24:25], v14 offset:0
    ds_read_b64_tr_b16 v[26:27], v14 offset:1024
    ds_read_b64_tr_b16 v[28:29], v15 offset:0
    ds_read_b64_tr_b16 v[30:31], v15 offset:1024
    s_waitcnt vmcnt(10) lgkmcnt(8)
    v_mfma_f32_32x32x16_bf16 v[32:47], v[152:155], v[232:235], v[32:47]
    v_mfma_f32_32x32x16_bf16 v[48:63], v[156:159], v[232:235], v[48:63]
    ds_read_b64_tr_b16 v[152:153], v14 offset:2048
    ds_read_b64_tr_b16 v[154:155], v14 offset:3072
    ds_read_b64_tr_b16 v[156:157], v15 offset:2048
    ds_read_b64_tr_b16 v[158:159], v15 offset:3072
    s_waitcnt vmcnt(9) lgkmcnt(8)
    v_mfma_f32_32x32x16_bf16 v[32:47], v[16:19], v[236:239], v[32:47]
    v_mfma_f32_32x32x16_bf16 v[48:63], v[20:23], v[236:239], v[48:63]
    s_cmp_lg_u32 s25, 0
    s_cbranch_scc1 ISS_2_3
    s_waitcnt vmcnt(0)
    v_cmp_eq_u32 s[100:101], 1, v135
    s_lshr_b32 s25, s100, 1
    s_and_b32 s25, s25, s100
    s_lshr_b32 s26, s25, 2
    s_and_b32 s29, s25, s26
    s_sub_u32 s25, 0, s24
    s_and_b32 s25, s25, s24
    s_and_b32 s25, s25, s29
    s_branch TRY_2_3
TRY_2_3:
    s_cmp_lg_u32 s25, 0
    s_cbranch_scc1 ISS_2_3
    buffer_load_dword v135, v131, s[8:11], s59 offen sc1
    v_xor_b32 v10, 0x2000, v14
    v_xor_b32 v11, 0x2000, v15
    ds_read_b64_tr_b16 v[16:17], v14 offset:4096
    ds_read_b64_tr_b16 v[18:19], v14 offset:5120
    ds_read_b64_tr_b16 v[20:21], v15 offset:4096
    ds_read_b64_tr_b16 v[22:23], v15 offset:5120
    s_waitcnt vmcnt(8) lgkmcnt(8)
    v_mfma_f32_32x32x16_bf16 v[32:47], v[24:27], v[64:67], v[32:47]
    v_mfma_f32_32x32x16_bf16 v[48:63], v[28:31], v[64:67], v[48:63]
    ds_read_b64_tr_b16 v[24:25], v14 offset:6144
    ds_read_b64_tr_b16 v[26:27], v14 offset:7168
    ds_read_b64_tr_b16 v[28:29], v15 offset:6144
    ds_read_b64_tr_b16 v[30:31], v15 offset:7168
    s_waitcnt vmcnt(7) lgkmcnt(8)
    v_mfma_f32_32x32x16_bf16 v[32:47], v[152:155], v[68:71], v[32:47]
    v_mfma_f32_32x32x16_bf16 v[48:63], v[156:159], v[68:71], v[48:63]
    ds_read_b64_tr_b16 v[152:153], v10 offset:0
    ds_read_b64_tr_b16 v[154:155], v10 offset:1024
    ds_read_b64_tr_b16 v[156:157], v11 offset:0
    ds_read_b64_tr_b16 v[158:159], v11 offset:1024
    s_waitcnt vmcnt(6) lgkmcnt(8)
    v_mfma_f32_32x32x16_bf16 v[32:47], v[16:19], v[72:75], v[32:47]
    v_mfma_f32_32x32x16_bf16 v[48:63], v[20:23], v[72:75], v[48:63]
    ds_read_b64_tr_b16 v[16:17], v10 offset:2048
    ds_read_b64_tr_b16 v[18:19], v10 offset:3072
    ds_read_b64_tr_b16 v[20:21], v11 offset:2048
    ds_read_b64_tr_b16 v[22:23], v11 offset:3072
    v_add_u32 v14, s19, v12
    v_add_u32 v15, s19, v13
    s_waitcnt vmcnt(5) lgkmcnt(8)
    v_mfma_f32_32x32x16_bf16 v[32:47], v[24:27], v[76:79], v[32:47]
    v_mfma_f32_32x32x16_bf16 v[48:63], v[28:31], v[76:79], v[48:63]
    ds_read_b64_tr_b16 v[24:25], v10 offset:4096
    ds_read_b64_tr_b16 v[26:27], v10 offset:5120
    ds_read_b64_tr_b16 v[28:29], v11 offset:4096
    ds_read_b64_tr_b16 v[30:31], v11 offset:5120
    s_waitcnt vmcnt(4) lgkmcnt(8)
    v_mfma_f32_32x32x16_bf16 v[32:47], v[152:155], v[80:83], v[32:47]
    v_mfma_f32_32x32x16_bf16 v[48:63], v[156:159], v[80:83], v[48:63]
    ds_read_b64_tr_b16 v[152:153], v10 offset:6144
    ds_read_b64_tr_b16 v[154:155], v10 offset:7168
    ds_read_b64_tr_b16 v[156:157], v11 offset:6144
    ds_read_b64_tr_b16 v[158:159], v11 offset:7168
    s_waitcnt vmcnt(3) lgkmcnt(8)
    v_mfma_f32_32x32x16_bf16 v[32:47], v[16:19], v[84:87], v[32:47]
    v_mfma_f32_32x32x16_bf16 v[48:63], v[20:23], v[84:87], v[48:63]
    ds_read_b64_tr_b16 v[16:17], v14 offset:0
    ds_read_b64_tr_b16 v[18:19], v14 offset:1024
    ds_read_b64_tr_b16 v[20:21], v15 offset:0
    ds_read_b64_tr_b16 v[22:23], v15 offset:1024
    s_waitcnt vmcnt(2) lgkmcnt(8)
    v_mfma_f32_32x32x16_bf16 v[32:47], v[24:27], v[88:91], v[32:47]
    v_mfma_f32_32x32x16_bf16 v[48:63], v[28:31], v[88:91], v[48:63]
    ds_read_b64_tr_b16 v[24:25], v14 offset:2048
    ds_read_b64_tr_b16 v[26:27], v14 offset:3072
    ds_read_b64_tr_b16 v[28:29], v15 offset:2048
    ds_read_b64_tr_b16 v[30:31], v15 offset:3072
    s_waitcnt vmcnt(1) lgkmcnt(8)
    v_mfma_f32_32x32x16_bf16 v[32:47], v[152:155], v[92:95], v[32:47]
    v_mfma_f32_32x32x16_bf16 v[48:63], v[156:159], v[92:95], v[48:63]
    s_cmp_lg_u32 s25, 0
    s_cbranch_scc1 ISS_3_3
    s_waitcnt vmcnt(0)
    v_cmp_eq_u32 s[100:101], 1, v135
    s_lshr_b32 s25, s100, 1
    s_and_b32 s25, s25, s100
    s_lshr_b32 s26, s25, 2
    s_and_b32 s29, s25, s26
    s_sub_u32 s25, 0, s24
    s_and_b32 s25, s25, s24
    s_and_b32 s25, s25, s29
    s_branch TRY_3_3
ISS_2_3:
    s_ff1_i32_b32 s26, s25
    s_bitset0_b32 s24, s26
    s_sub_u32 s25, 0, s24
    s_and_b32 s25, s25, s24
    s_and_b32 s25, s25, s29
    s_xor_b32 s26, s26, s61
    s_lshl_b32 s27, s26, 11
    s_add_u32 s27, s27, s60
    s_add_u32 s27, s27, s30
    s_xor_b32 s28, s27, 4096
    s_lshl_b32 s19, s26, 12
    buffer_load_dwordx4 v[96:99], v1, s[8:11], s27 offen offset:0 sc1
    buffer_load_dwordx4 v[100:103], v1, s[8:11], s27 offen offset:1024 sc1
    buffer_load_dwordx4 v[104:107], v1, s[8:11], s27 offen offset:2048 sc1
    buffer_load_dwordx4 v[108:111], v1, s[8:11], s27 offen offset:3072 sc1
    buffer_load_dwordx4 v[240:243], v1, s[8:11], s28 offen offset:0 sc1
    buffer_load_dwordx4 v[244:247], v1, s[8:11], s28 offen offset:1024 sc1
    buffer_load_dwordx4 v[248:251], v1, s[8:11], s28 offen offset:2048 sc1
    buffer_load_dwordx4 v[252:255], v1, s[8:11], s28 offen offset:3072 sc1
    s_branch TRY_2_4
TRY_3_3:
    s_cmp_lg_u32 s25, 0
    s_cbranch_scc1 ISS_3_3
POL_3:
    buffer_load_dword v135, v131, s[8:11], s59 offen sc1
    s_waitcnt vmcnt(0)
    v_cmp_eq_u32 s[100:101], 1, v135
    s_lshr_b32 s25, s100, 1
    s_and_b32 s25, s25, s100
    s_lshr_b32 s26, s25, 2
    s_and_b32 s29, s25, s26
    s_sub_u32 s25, 0, s24
    s_and_b32 s25, s25, s24
    s_and_b32 s25, s25, s29
    s_cbranch_scc1 ISS_3_3
    s_sleep 3
    s_add_u32 s98, s98, 1
    s_cmp_lt_u32 s98, 0x80000
    s_cbranch_scc1 POL_3
    s_branch P3_RED
ISS_3_3:
    s_ff1_i32_b32 s26, s25
    s_bitset0_b32 s24, s26
    s_sub_u32 s25, 0, s24
    s_and_b32 s25, s25, s24
    s_and_b32 s25, s25, s29
    s_xor_b32 s26, s26, s61
    s_lshl_b32 s27, s26, 11
    s_add_u32 s27, s27, s60
    s_add_u32 s27, s27, s30
    s_xor_b32 s28, s27, 4096
    s_lshl_b32 s19, s26, 12
    buffer_load_dwordx4 v[96:99], v1, s[8:11], s27 offen offset:0 sc1
    buffer_load_dwordx4 v[100:103], v1, s[8:11], s27 offen offset:1024 sc1
    buffer_load_dwordx4 v[104:107], v1, s[8:11], s27 offen offset:2048 sc1
    buffer_load_dwordx4 v[108:111], v1, s[8:11], s27 offen offset:3072 sc1
    buffer_load_dwordx4 v[240:243], v1, s[8:11], s28 offen offset:0 sc1
    buffer_load_dwordx4 v[244:247], v1, s[8:11], s28 offen offset:1024 sc1
    buffer_load_dwordx4 v[248:251], v1, s[8:11], s28 offen offset:2048 sc1
    buffer_load_dwordx4 v[252:255], v1, s[8:11], s28 offen offset:3072 sc1
    s_branch TRY_3_4
TRY_2_4:
    v_xor_b32 v10, 0x2000, v14
    v_xor_b32 v11, 0x2000, v15
    ds_read_b64_tr_b16 v[16:17], v14 offset:4096
    ds_read_b64_tr_b16 v[18:19], v14 offset:5120
    ds_read_b64_tr_b16 v[20:21], v15 offset:4096
    ds_read_b64_tr_b16 v[22:23], v15 offset:5120
    s_waitcnt vmcnt(15) lgkmcnt(8)
    v_mfma_f32_32x32x16_bf16 v[32:47], v[24:27], v[64:67], v[32:47]
    v_mfma_f32_32x32x16_bf16 v[48:63], v[28:31], v[64:67], v[48:63]
    ds_read_b64_tr_b16 v[24:25], v14 offset:6144
    ds_read_b64_tr_b16 v[26:27], v14 offset:7168
    ds_read_b64_tr_b16 v[28:29], v15 offset:6144
    ds_read_b64_tr_b16 v[30:31], v15 offset:7168
    s_waitcnt vmcnt(14) lgkmcnt(8)
    v_mfma_f32_32x32x16_bf16 v[32:47], v[152:155], v[68:71], v[32:47]
    v_mfma_f32_32x32x16_bf16 v[48:63], v[156:159], v[68:71], v[48:63]
    ds_read_b64_tr_b16 v[152:153], v10 offset:0
    ds_read_b64_tr_b16 v[154:155], v10 offset:1024
    ds_read_b64_tr_b16 v[156:157], v11 offset:0
    ds_read_b64_tr_b16 v[158:159], v11 offset:1024
    s_waitcnt vmcnt(13) lgkmcnt(8)
    v_mfma_f32_32x32x16_bf16 v[32:47], v[16:19], v[72:75], v[32:47]
    v_mfma_f32_32x32x16_bf16 v[48:63], v[20:23], v[72:75], v[48:63]
    ds_read_b64_tr_b16 v[16:17], v10 offset:2048
    ds_read_b64_tr_b16 v[18:19], v10 offset:3072
    ds_read_b64_tr_b16 v[20:21], v11 offset:2048
    ds_read_b64_tr_b16 v[22:23], v11 offset:3072
    v_add_u32 v14, s19, v12
    v_add_u32 v15, s19, v13
    s_waitcnt vmcnt(12) lgkmcnt(8)
    v_mfma_f32_32x32x16_bf16 v[32:47], v[24:27], v[76:79], v[32:47]
    v_mfma_f32_32x32x16_bf16 v[48:63], v[28:31], v[76:79], v[48:63]
    ds_read_b64_tr_b16 v[24:25], v10 offset:4096
    ds_read_b64_tr_b16 v[26:27], v10 offset:5120
    ds_read_b64_tr_b16 v[28:29], v11 offset:4096
    ds_read_b64_tr_b16 v[30:31], v11 offset:5120
    s_waitcnt vmcnt(11) lgkmcnt(8)
    v_mfma_f32_32x32x16_bf16 v[32:47], v[152:155], v[80:83], v[32:47]
    v_mfma_f32_32x32x16_bf16 v[48:63], v[156:159], v[80:83], v[48:63]
    ds_read_b64_tr_b16 v[152:153], v10 offset:6144
    ds_read_b64_tr_b16 v[154:155], v10 offset:7168
    ds_read_b64_tr_b16 v[156:157], v11 offset:6144
    ds_read_b64_tr_b16 v[158:159], v11 offset:7168
    s_waitcnt vmcnt(10) lgkmcnt(8)
    v_mfma_f32_32x32x16_bf16 v[32:47], v[16:19], v[84:87], v[32:47]
    v_mfma_f32_32x32x16_bf16 v[48:63], v[20:23], v[84:87], v[48:63]
    ds_read_b64_tr_b16 v[16:17], v14 offset:0
    ds_read_b64_tr_b16 v[18:19], v14 offset:1024
    ds_read_b64_tr_b16 v[20:21], v15 offset:0
    ds_read_b64_tr_b16 v[22:23], v15 offset:1024
    s_waitcnt vmcnt(9) lgkmcnt(8)
    v_mfma_f32_32x32x16_bf16 v[32:47], v[24:27], v[88:91], v[32:47]
    v_mfma_f32_32x32x16_bf16 v[48:63], v[28:31], v[88:91], v[48:63]
    ds_read_b64_tr_b16 v[24:25], v14 offset:2048
    ds_read_b64_tr_b16 v[26:27], v14 offset:3072
    ds_read_b64_tr_b16 v[28:29], v15 offset:2048
    ds_read_b64_tr_b16 v[30:31], v15 offset:3072
    s_waitcnt vmcnt(8) lgkmcnt(8)
    v_mfma_f32_32x32x16_bf16 v[32:47], v[152:155], v[92:95], v[32:47]
    v_mfma_f32_32x32x16_bf16 v[48:63], v[156:159], v[92:95], v[48:63]
TRY_3_4:
    v_xor_b32 v10, 0x2000, v14
    v_xor_b32 v11, 0x2000, v15
    ds_read_b64_tr_b16 v[152:153], v14 offset:4096
    ds_read_b64_tr_b16 v[154:155], v14 offset:5120
    ds_read_b64_tr_b16 v[156:157], v15 offset:4096
    ds_read_b64_tr_b16 v[158:159], v15 offset:5120
    s_waitcnt vmcnt(7) lgkmcnt(8)
    v_mfma_f32_32x32x16_bf16 v[32:47], v[16:19], v[96:99], v[32:47]
    v_lshlrev_b32 v112, 16, v136
    v_lshlrev_b32 v113, 16, v137
    v_lshlrev_b32 v114, 16, v144
    v_and_b32 v115, 0xffff0000, v144
    v_mfma_f32_32x32x16_bf16 v[48:63], v[20:23], v[96:99], v[48:63]
    v_mul_f32 v112, v112, v114
    v_mul_f32 v113, v113, v115
    v_cvt_pk_bf16_f32 v144, v112, v113
    ds_read_b64_tr_b16 v[16:17], v14 offset:6144
    ds_read_b64_tr_b16 v[18:19], v14 offset:7168
    ds_read_b64_tr_b16 v[20:21], v15 offset:6144
    ds_read_b64_tr_b16 v[22:23], v15 offset:7168
    s_waitcnt vmcnt(6) lgkmcnt(8)
    v_mfma_f32_32x32x16_bf16 v[32:47], v[24:27], v[100:103], v[32:47]
    v_lshlrev_b32 v112, 16, v138
    v_lshlrev_b32 v113, 16, v139
    v_lshlrev_b32 v114, 16, v145
    v_and_b32 v115, 0xffff0000, v145
    v_mfma_f32_32x32x16_bf16 v[48:63], v[28:31], v[100:103], v[48:63]
    v_mul_f32 v112, v112, v114
    v_mul_f32 v113, v113, v115
    v_cvt_pk_bf16_f32 v145, v112, v113
    ds_read_b64_tr_b16 v[24:25], v10 offset:0
    ds_read_b64_tr_b16 v[26:27], v10 offset:1024
    ds_read_b64_tr_b16 v[28:29], v11 offset:0
    ds_read_b64_tr_b16 v[30:31], v11 offset:1024
    s_waitcnt vmcnt(5) lgkmcnt(8)
    v_mfma_f32_32x32x16_bf16 v[32:47], v[152:155], v[104:107], v[32:47]
    v_lshlrev_b32 v112, 16, v140
    v_lshlrev_b32 v113, 16, v141
    v_lshlrev_b32 v114, 16, v146
    v_and_b32 v115, 0xffff0000, v146
    v_mfma_f32_32x32x16_bf16 v[48:63], v[156:159], v[104:107], v[48:63]
    v_mul_f32 v112, v112, v114
    v_mul_f32 v113, v113, v115
    v_cvt_pk_bf16_f32 v146, v112, v113
    ds_read_b64_tr_b16 v[152:153], v10 offset:2048
    ds_read_b64_tr_b16 v[154:155], v10 offset:3072
    ds_read_b64_tr_b16 v[156:157], v11 offset:2048
    ds_read_b64_tr_b16 v[158:159], v11 offset:3072
    s_waitcnt vmcnt(4) lgkmcnt(8)
    v_mfma_f32_32x32x16_bf16 v[32:47], v[16:19], v[108:111], v[32:47]
    v_lshlrev_b32 v112, 16, v142
    v_lshlrev_b32 v113, 16, v143
    v_lshlrev_b32 v114, 16, v147
    v_and_b32 v115, 0xffff0000, v147
    v_mfma_f32_32x32x16_bf16 v[48:63], v[20:23], v[108:111], v[48:63]
    v_mul_f32 v112, v112, v114
    v_mul_f32 v113, v113, v115
    v_cvt_pk_bf16_f32 v147, v112, v113
    ds_read_b64_tr_b16 v[16:17], v10 offset:4096
    ds_read_b64_tr_b16 v[18:19], v10 offset:5120
    ds_read_b64_tr_b16 v[20:21], v11 offset:4096
    ds_read_b64_tr_b16 v[22:23], v11 offset:5120
    s_waitcnt vmcnt(3) lgkmcnt(8)
    v_mfma_f32_32x32x16_bf16 v[32:47], v[24:27], v[240:243], v[32:47]
    v_and_b32 v112, 0xffff0000, v136
    v_and_b32 v113, 0xffff0000, v137
    v_lshlrev_b32 v114, 16, v148
    v_and_b32 v115, 0xffff0000, v148
    v_mfma_f32_32x32x16_bf16 v[48:63], v[28:31], v[240:243], v[48:63]
    v_mul_f32 v112, v112, v114
    v_mul_f32 v113, v113, v115
    v_cvt_pk_bf16_f32 v148, v112, v113
    ds_read_b64_tr_b16 v[24:25], v10 offset:6144
    ds_read_b64_tr_b16 v[26:27], v10 offset:7168
    ds_read_b64_tr_b16 v[28:29], v11 offset:6144
    ds_read_b64_tr_b16 v[30:31], v11 offset:7168
    s_waitcnt vmcnt(2) lgkmcnt(8)
    v_mfma_f32_32x32x16_bf16 v[32:47], v[152:155], v[244:247], v[32:47]
    v_and_b32 v112, 0xffff0000, v138
    v_and_b32 v113, 0xffff0000, v139
    v_lshlrev_b32 v114, 16, v149
    v_and_b32 v115, 0xffff0000, v149
    v_mfma_f32_32x32x16_bf16 v[48:63], v[156:159], v[244:247], v[48:63]
    v_mul_f32 v112, v112, v114
    v_mul_f32 v113, v113, v115
    v_cvt_pk_bf16_f32 v149, v112, v113
    s_waitcnt vmcnt(1) lgkmcnt(4)
    v_mfma_f32_32x32x16_bf16 v[32:47], v[16:19], v[248:251], v[32:47]
    v_and_b32 v112, 0xffff0000, v140
    v_and_b32 v113, 0xffff0000, v141
    v_lshlrev_b32 v114, 16, v150
    v_and_b32 v115, 0xffff0000, v150
    v_mfma_f32_32x32x16_bf16 v[48:63], v[20:23], v[248:251], v[48:63]
    v_mul_f32 v112, v112, v114
    v_mul_f32 v113, v113, v115
    v_cvt_pk_bf16_f32 v150, v112, v113
    s_waitcnt vmcnt(0) lgkmcnt(0)
    v_mfma_f32_32x32x16_bf16 v[32:47], v[24:27], v[252:255], v[32:47]
    v_and_b32 v112, 0xffff0000, v142
    v_and_b32 v113, 0xffff0000, v143
    v_lshlrev_b32 v114, 16, v151
    v_and_b32 v115, 0xffff0000, v151
    v_mfma_f32_32x32x16_bf16 v[48:63], v[28:31], v[252:255], v[48:63]
    v_mul_f32 v112, v112, v114
    v_mul_f32 v113, v113, v115
    v_cvt_pk_bf16_f32 v151, v112, v113
    buffer_store_dwordx4 v[144:147], v133, s[52:55], 0 offen sc1
    buffer_store_dwordx4 v[148:151], v133, s[52:55], s13 offen sc1
P3_RED:
    s_nop 7
    s_nop 3
    ds_write_b128 v6, v[48:51] offset:0
    ds_write_b128 v6, v[52:55] offset:1024
    ds_write_b128 v6, v[56:59] offset:2048
    ds_write_b128 v6, v[60:63] offset:3072
    s_waitcnt lgkmcnt(0)
    s_barrier
    ds_read_b128 v[64:67], v7 offset:0
    ds_read_b128 v[68:71], v7 offset:1024
    ds_read_b128 v[72:75], v7 offset:2048
    ds_read_b128 v[76:79], v7 offset:3072
    s_waitcnt lgkmcnt(3)
    v_add_f32 v32, v32, v64
    v_add_f32 v33, v33, v65
    v_add_f32 v34, v34, v66
    v_add_f32 v35, v35, v67
    s_waitcnt lgkmcnt(2)
    v_add_f32 v36, v36, v68
    v_add_f32 v37, v37, v69
    v_add_f32 v38, v38, v70
    v_add_f32 v39, v39, v71
    s_waitcnt lgkmcnt(1)
    v_add_f32 v40, v40, v72
    v_add_f32 v41, v41, v73
    v_add_f32 v42, v42, v74
    v_add_f32 v43, v43, v75
    s_waitcnt lgkmcnt(0)
    v_add_f32 v44, v44, v76
    v_add_f32 v45, v45, v77
    v_add_f32 v46, v46, v78
    v_add_f32 v47, v47, v79
    v_cvt_pk_bf16_f32 v16, v32, v33
    v_cvt_pk_bf16_f32 v17, v34, v35
    v_cvt_pk_bf16_f32 v18, v36, v37
    v_cvt_pk_bf16_f32 v19, v38, v39
    v_cvt_pk_bf16_f32 v20, v40, v41
    v_cvt_pk_bf16_f32 v21, v42, v43
    v_cvt_pk_bf16_f32 v22, v44, v45
    v_cvt_pk_bf16_f32 v23, v46, v47
    ds_write_b128 v8, v[16:19]
    ds_write_b128 v9, v[20:23]
    ds_read_b128 v[24:27], v7
    ds_read_b128 v[28:31], v7 offset:1024
    s_waitcnt lgkmcnt(1)
    buffer_store_dwordx4 v[24:27], v5, s[52:55], s14 offen sc1
    s_waitcnt lgkmcnt(0)
    buffer_store_dwordx4 v[28:31], v5, s[52:55], s15 offen sc1
K_END:
    s_endpgm
P2_SLOW:
    v_mov_b32 v12, 0xff7fffff
    s_mov_b32 s50, s6
    s_mov_b32 s49, 0
P2_SLOW1:
    buffer_load_dwordx4 v[92:95], v1, s[8:11], s50 offen sc1
    buffer_load_dwordx4 v[96:99], v1, s[8:11], s50 offen offset:1024 sc1
    s_waitcnt vmcnt(0)
    v_mfma_f32_32x32x16_bf16 v[48:63], v[92:95], v[4:7], 0
    v_mfma_f32_32x32x16_bf16 v[48:63], v[96:99], v[8:11], v[48:63]
    s_nop 7
    s_nop 3
    v_max3_f32 v12, v12, v48, v49
    v_max3_f32 v12, v12, v50, v51
    v_max3_f32 v12, v12, v52, v53
    v_max3_f32 v12, v12, v54, v55
    v_max3_f32 v12, v12, v56, v57
    v_max3_f32 v12, v12, v58, v59
    v_max3_f32 v12, v12, v60, v61
    v_max3_f32 v12, v12, v62, v63
    s_add_u32 s50, s50, 4096
    s_add_u32 s49, s49, 1
    s_cmp_lt_u32 s49, 64
    s_cbranch_scc1 P2_SLOW1
    v_mov_b32 v13, v12
    s_nop 1
    v_permlane32_swap_b32 v12, v13
    v_max_f32 v12, v12, v13
    v_xor_b32 v16, 0x80000000, v12
    v_mov_b32 v72, 0
    v_xor_b32 v17, 0x80000000, v12
    v_mov_b32 v73, 0
    v_xor_b32 v18, 0x80000000, v12
    v_mov_b32 v74, 0
    v_xor_b32 v19, 0x80000000, v12
    v_mov_b32 v75, 0
    v_xor_b32 v20, 0x80000000, v12
    v_mov_b32 v76, 0
    v_xor_b32 v21, 0x80000000, v12
    v_mov_b32 v77, 0
    v_xor_b32 v22, 0x80000000, v12
    v_mov_b32 v78, 0
    v_xor_b32 v23, 0x80000000, v12
    v_mov_b32 v79, 0
    v_xor_b32 v24, 0x80000000, v12
    v_mov_b32 v80, 0
    v_xor_b32 v25, 0x80000000, v12
    v_mov_b32 v81, 0
    v_xor_b32 v26, 0x80000000, v12
    v_mov_b32 v82, 0
    v_xor_b32 v27, 0x80000000, v12
    v_mov_b32 v83, 0
    v_xor_b32 v28, 0x80000000, v12
    v_mov_b32 v84, 0
    v_xor_b32 v29, 0x80000000, v12
    v_mov_b32 v85, 0
    v_xor_b32 v30, 0x80000000, v12
    v_mov_b32 v86, 0
    v_xor_b32 v31, 0x80000000, v12
    v_mov_b32 v87, 0
    v_mov_b32 v88, 0
    v_mov_b32 v89, 0
    v_mov_b32 v90, 0
    v_mov_b32 v91, 0
    s_mov_b32 s50, s6
    s_mov_b32 s49, 0
P2_SLOW2:
    buffer_load_dwordx4 v[92:95], v1, s[8:11], s50 offen sc1
    buffer_load_dwordx4 v[96:99], v1, s[8:11], s50 offen offset:1024 sc1
    buffer_load_dwordx4 v[108:111], v1, s[8:11], s50 offen offset:2048 sc1
    buffer_load_dwordx4 v[112:115], v1, s[8:11], s50 offen offset:3072 sc1
    s_waitcnt vmcnt(0)
    v_mfma_f32_32x32x16_bf16 v[48:63], v[92:95], v[4:7], v[16:31]
    v_mfma_f32_32x32x16_bf16 v[48:63], v[96:99], v[8:11], v[48:63]
    s_nop 7
    s_nop 3
    v_exp_f32 v48, v48
    v_exp_f32 v49, v49
    v_exp_f32 v50, v50
    v_exp_f32 v51, v51
    v_exp_f32 v52, v52
    v_exp_f32 v53, v53
    v_exp_f32 v54, v54
    v_exp_f32 v55, v55
    v_exp_f32 v56, v56
    v_exp_f32 v57, v57
    v_exp_f32 v58, v58
    v_exp_f32 v59, v59
    v_exp_f32 v60, v60
    v_exp_f32 v61, v61
    v_exp_f32 v62, v62
    v_exp_f32 v63, v63
    s_nop 0
    v_cvt_pk_bf16_f32 v64, v48, v49
    v_cvt_pk_bf16_f32 v65, v50, v51
    v_cvt_pk_bf16_f32 v66, v52, v53
    v_cvt_pk_bf16_f32 v67, v54, v55
    v_cvt_pk_bf16_f32 v68, v56, v57
    v_cvt_pk_bf16_f32 v69, v58, v59
    v_cvt_pk_bf16_f32 v70, v60, v61
    v_cvt_pk_bf16_f32 v71, v62, v63
    s_nop 1
    v_mfma_f32_32x32x16_bf16 v[72:87], v[108:111], v[64:67], v[72:87]
    v_mfma_f32_32x32x16_bf16 v[72:87], v[112:115], v[68:71], v[72:87]
    v_smfmac_f32_16x16x64_bf16 v[88:91], v[124:127], v[64:71], v15
    s_add_u32 s50, s50, 4096
    s_add_u32 s49, s49, 1
    s_cmp_lt_u32 s49, 64
    s_cbranch_scc1 P2_SLOW2
    s_nop 7
    s_nop 3
    v_add_f32 v88, v88, v89
    v_rcp_f32 v12, v88
    s_nop 0
    s_branch P2_FIN
K_LAST:
.fill 2018, 4, 0xbf810000
.section .rodata,"a"
.p2align 6
.amdhsa_kernel concat_heads__ssm_conv_h3__mha_block__prompt_kernel
  .amdhsa_next_free_vgpr 256
  .amdhsa_next_free_sgpr 102
  .amdhsa_accum_offset 256
  .amdhsa_group_segment_fixed_size 0
  .amdhsa_kernarg_size 96
  .amdhsa_user_sgpr_count 2
  .amdhsa_user_sgpr_kernarg_segment_ptr 1
  .amdhsa_system_sgpr_workgroup_id_x 1
.end_amdhsa_kernel
```
